```python
import torch

def _softmax(x, axis=-1):
    return torch.softmax(x, dim=axis)
def _gelu(x):
    return torch.nn.functional.gelu(x, approximate="tanh")
def _silu(x):
    return torch.nn.functional.silu(x)
def _sigmoid(x):
    return torch.sigmoid(x)
def _layernorm(x, axis=-1, eps=1e-5):
    m = x.mean(dim=axis, keepdim=True)
    v = x.var(dim=axis, keepdim=True, unbiased=False)
    return (x - m) / torch.sqrt(v + eps)
def _scatter_add(tgt, idx, src, axis=0):
    return tgt.clone().index_add_(axis, idx, src)
def _segment_sum(src, seg, n):
    out = torch.zeros((n,) + src.shape[1:], dtype=src.dtype)
    return out.index_add_(0, seg, src)
def _pad(x, pw):
    flat = tuple(v for pair in reversed(pw) for v in pair)
    return torch.nn.functional.pad(x, flat)

kernel_name = 'standalone__gqa_block_cached__near_ridge'

def setup_inputs():

    _w = (lambda a: (lambda t: t.to(torch.bfloat16) if t.is_floating_point() else t)(torch.as_tensor(a)))
    B, Sq, D = 8, 64, 512
    Hq, Hkv, Sk, Dh = 32, 8, 2048, 128
    assert Hq % Hkv == 0, (Hq, Hkv)
    return {
        "x": _w((lambda *s: torch.randn(*s, dtype=torch.bfloat16) * 0.8)(B, Sq, D)),
        "k_cache": _w((lambda *s: torch.randn(*s, dtype=torch.bfloat16) * 0.8)(B, Hkv, Sk, Dh)),
        "v_cache": _w((lambda *s: torch.randn(*s, dtype=torch.bfloat16) * 0.05)(B, Hkv, Sk, Dh)),
        "wq": _w((lambda *s: torch.randn(*s, dtype=torch.bfloat16) * 0.8)(D, Hq * Dh) * (D ** -0.5)),
        "wo": _w((lambda *s: torch.randn(*s, dtype=torch.bfloat16) * 0.05)(Hq * Dh, D) * ((Hq * Dh) ** -0.5)),
    }

def reference(x, k_cache, v_cache, wq, wo):
    B, Sq, D = x.shape
    Hq, Dh = 32, 128
    Hkv = k_cache.shape[1]
    rep = Hq // Hkv
    q = (lambda x, *d: x.permute(*d))((x @ wq).reshape(B, Sq, Hq, Dh), 0, 2, 1, 3)
    k = (lambda x, n, axis: torch.repeat_interleave(x, n, dim=axis))(k_cache, rep, axis=1)
    v = (lambda x, n, axis: torch.repeat_interleave(x, n, dim=axis))(v_cache, rep, axis=1)
    scores = torch.einsum("bhqd,bhkd->bhqk", q, k) * (Dh ** -0.5)
    p = _softmax(scores, axis=-1)
    o = torch.einsum("bhqk,bhkd->bhqd", p, v)
    return (lambda x, *d: x.permute(*d))(o, 0, 2, 1, 3).reshape(B, Sq, Hq * Dh) @ wo
```

```asm
; @launch grid=(256,1,1) block=(256,1,1) lds=163840
.amdgcn_target "amdgcn-amd-amdhsa--gfx950"
.text
.globl standalone__gqa_block_cached__near_ridge_kernel
.p2align 8
.type standalone__gqa_block_cached__near_ridge_kernel,@function
standalone__gqa_block_cached__near_ridge_kernel:
F_begin:
    s_cmp_ge_u32 s2, 256
    s_cbranch_scc1 F_end
    s_load_dwordx4 s[4:7], s[0:1], 0
    s_load_dwordx4 s[8:11], s[0:1], 16
    s_load_dwordx4 s[56:59], s[0:1], 32
    s_load_dwordx2 s[60:61], s[0:1], 48
    s_load_dwordx2 s[64:65], s[0:1], 56
    s_memrealtime s[98:99]
    v_lshrrev_b32 v1, 6, v0
    v_and_b32 v2, 63, v0
    v_readfirstlane_b32 s24, v1
    s_and_b32 s25, s2, 7
    s_lshr_b32 s26, s2, 3
    s_and_b32 s27, s26, 3
    s_lshr_b32 s26, s26, 2
    s_lshl_b32 s28, s26, 3
    s_add_u32 s28, s28, s25
    v_lshrrev_b32 v4, 5, v2
    v_and_b32 v5, 15, v2
    v_lshrrev_b32 v6, 4, v2
    v_lshlrev_b32 v13, 4, v2
    v_xor_b32 v7, v5, v6
    v_lshlrev_b32 v9, 10, v6
    v_xor_b32 v8, 0, v7
    v_lshlrev_b32 v8, 4, v8
    v_add_u32 v44, v8, v9
    v_xor_b32 v8, 4, v7
    v_lshlrev_b32 v8, 4, v8
    v_add_u32 v45, v8, v9
    v_xor_b32 v8, 8, v7
    v_lshlrev_b32 v8, 4, v8
    v_add_u32 v46, v8, v9
    v_xor_b32 v8, 12, v7
    v_lshlrev_b32 v8, 4, v8
    v_add_u32 v47, v8, v9
    v_lshlrev_b32 v8, 2, v6
    v_xor_b32 v8, v5, v8
    v_lshlrev_b32 v3, 4, v8
    v_lshlrev_b32 v8, 13, v6
    v_add_u32 v48, v3, v8
    v_add_u32 v49, v3, v9
    s_add_u32 s33, s26, s27
    s_and_b32 s33, s33, 3
    s_waitcnt lgkmcnt(0)
    s_lshl_b32 s34, s26, 16
    s_add_u32 s40, s4, s34
    s_addc_u32 s41, s5, 0
    s_mov_b32 s42, 65536
    s_mov_b32 s43, 0x20000
    s_lshl_b32 s34, s25, 2
    s_add_u32 s34, s34, s27
    s_lshl_b32 s34, s34, 8
    s_add_u32 s44, s10, s34
    s_addc_u32 s45, s11, 0
    s_sub_u32 s46, 4194304, s34
    s_mov_b32 s47, 0x20000
    s_add_u32 s34, s33, 0
    s_and_b32 s34, s34, 3
    s_lshl_b32 s35, s34, 8
    s_lshl_b32 s36, s24, 14
    s_add_u32 s35, s35, s36
    s_lshl_b32 s36, s24, 12
    s_add_u32 m0, s36, 0
    s_add_u32 s31, s35, 0
    buffer_load_dwordx4 v44, s[40:43], s31 offen lds
    s_add_u32 m0, s36, 1024
    s_add_u32 s31, s35, 4096
    buffer_load_dwordx4 v45, s[40:43], s31 offen lds
    s_add_u32 m0, s36, 2048
    s_add_u32 s31, s35, 8192
    buffer_load_dwordx4 v46, s[40:43], s31 offen lds
    s_add_u32 m0, s36, 3072
    s_add_u32 s31, s35, 12288
    buffer_load_dwordx4 v47, s[40:43], s31 offen lds
    s_lshl_b32 s35, s34, 20
    s_lshl_b32 s36, s24, 18
    s_add_u32 s35, s35, s36
    s_lshl_b32 s36, s24, 13
    s_add_u32 m0, s36, 16384
    s_add_u32 s31, s35, 0
    buffer_load_dwordx4 v48, s[44:47], s31 offen lds
    s_add_u32 m0, s36, 17408
    s_add_u32 s31, s35, 32768
    buffer_load_dwordx4 v48, s[44:47], s31 offen lds
    s_add_u32 m0, s36, 18432
    s_add_u32 s31, s35, 65536
    buffer_load_dwordx4 v48, s[44:47], s31 offen lds
    s_add_u32 m0, s36, 19456
    s_add_u32 s31, s35, 98304
    buffer_load_dwordx4 v48, s[44:47], s31 offen lds
    s_add_u32 m0, s36, 20480
    s_add_u32 s31, s35, 131072
    buffer_load_dwordx4 v48, s[44:47], s31 offen lds
    s_add_u32 m0, s36, 21504
    s_add_u32 s31, s35, 163840
    buffer_load_dwordx4 v48, s[44:47], s31 offen lds
    s_add_u32 m0, s36, 22528
    s_add_u32 s31, s35, 196608
    buffer_load_dwordx4 v48, s[44:47], s31 offen lds
    s_add_u32 m0, s36, 23552
    s_add_u32 s31, s35, 229376
    buffer_load_dwordx4 v48, s[44:47], s31 offen lds
    s_mov_b32 s20, s64
    s_mov_b32 s21, s65
    s_mov_b32 s22, 0x3000000
    s_mov_b32 s23, 0x20000
    s_mov_b32 s48, s56
    s_mov_b32 s49, s57
    s_mov_b32 s50, 4194304
    s_mov_b32 s51, 0x20000
    s_lshl_b32 s34, s28, 19
    s_add_u32 s12, s6, s34
    s_addc_u32 s13, s7, 0
    s_mov_b32 s14, 524288
    s_mov_b32 s15, 0x20000
    s_add_u32 s16, s8, s34
    s_addc_u32 s17, s9, 0
    s_mov_b32 s18, 524288
    s_mov_b32 s19, 0x20000
    s_getreg_b32 s37, hwreg(HW_REG_XCC_ID)
    s_and_b32 s37, s37, 15
    s_lshl_b32 s29, s27, 17
    s_lshl_b32 s30, s24, 11
    s_add_u32 s29, s29, s30
    s_mov_b32 s32, 0x45800000
    s_mov_b32 s68, 0
    s_mov_b32 s69, 0
    s_cmp_eq_u32 s24, 0
    s_cbranch_scc0 F_early_done
    s_lshl_b32 s34, s2, 7
    s_add_u32 s34, s34, 0x2820000
    v_mov_b32 v16, s98
    v_mov_b32 v17, s99
    v_mov_b32 v18, s37
    v_mov_b32 v19, 0
    v_mov_b32 v7, 0
    s_mov_b64 exec, 1
    buffer_store_dwordx4 v[16:19], v7, s[20:23], s34 offen sc1
    s_cmp_eq_u32 s2, 0
    s_cbranch_scc0 F_early_x
    s_or_b32 s38, s98, 1
    v_mov_b32 v8, s38
    v_mov_b32 v9, s99
    global_store_dwordx2 v7, v[8:9], s[60:61] sc1
F_early_x:
    s_mov_b64 exec, -1
F_early_done:
    s_add_u32 s34, s33, 1
    s_and_b32 s34, s34, 3
    s_lshl_b32 s35, s34, 8
    s_lshl_b32 s36, s24, 14
    s_add_u32 s35, s35, s36
    s_lshl_b32 s36, s24, 12
    s_add_u32 m0, s36, 49152
    s_add_u32 s31, s35, 0
    buffer_load_dwordx4 v44, s[40:43], s31 offen lds
    s_add_u32 m0, s36, 50176
    s_add_u32 s31, s35, 4096
    buffer_load_dwordx4 v45, s[40:43], s31 offen lds
    s_add_u32 m0, s36, 51200
    s_add_u32 s31, s35, 8192
    buffer_load_dwordx4 v46, s[40:43], s31 offen lds
    s_add_u32 m0, s36, 52224
    s_add_u32 s31, s35, 12288
    buffer_load_dwordx4 v47, s[40:43], s31 offen lds
    s_lshl_b32 s35, s34, 20
    s_lshl_b32 s36, s24, 18
    s_add_u32 s35, s35, s36
    s_lshl_b32 s36, s24, 13
    s_add_u32 m0, s36, 65536
    s_add_u32 s31, s35, 0
    buffer_load_dwordx4 v48, s[44:47], s31 offen lds
    s_add_u32 m0, s36, 66560
    s_add_u32 s31, s35, 32768
    buffer_load_dwordx4 v48, s[44:47], s31 offen lds
    s_add_u32 m0, s36, 67584
    s_add_u32 s31, s35, 65536
    buffer_load_dwordx4 v48, s[44:47], s31 offen lds
    s_add_u32 m0, s36, 68608
    s_add_u32 s31, s35, 98304
    buffer_load_dwordx4 v48, s[44:47], s31 offen lds
    s_add_u32 m0, s36, 69632
    s_add_u32 s31, s35, 131072
    buffer_load_dwordx4 v48, s[44:47], s31 offen lds
    s_add_u32 m0, s36, 70656
    s_add_u32 s31, s35, 163840
    buffer_load_dwordx4 v48, s[44:47], s31 offen lds
    s_add_u32 m0, s36, 71680
    s_add_u32 s31, s35, 196608
    buffer_load_dwordx4 v48, s[44:47], s31 offen lds
    s_add_u32 m0, s36, 72704
    s_add_u32 s31, s35, 229376
    buffer_load_dwordx4 v48, s[44:47], s31 offen lds
    v_lshlrev_b32 v9, 8, v6
    v_add_u32 v12, v3, v9
    v_xor_b32 v7, v5, v6
    s_and_b32 s34, s24, 1
    s_lshl_b32 s34, s34, 3
    v_xor_b32 v8, s34, v7
    v_lshlrev_b32 v10, 4, v8
    v_add_u32 v10, v10, v9
    v_xor_b32 v8, 4, v8
    v_lshlrev_b32 v11, 4, v8
    v_add_u32 v11, v11, v9
    v_and_b32 v8, 15, v2
    v_xor_b32 v8, v8, v4
    v_lshlrev_b32 v8, 4, v8
    v_and_b32 v9, 31, v2
    v_lshlrev_b32 v9, 8, v9
    v_add_u32 v8, v8, v9
    v_xor_b32 v20, 0, v8
    v_xor_b32 v21, 32, v8
    v_xor_b32 v22, 64, v8
    v_xor_b32 v23, 96, v8
    v_xor_b32 v24, 128, v8
    v_xor_b32 v25, 160, v8
    v_xor_b32 v26, 192, v8
    v_xor_b32 v27, 224, v8
    v_bfe_u32 v56, v2, 2, 2
    v_bfe_u32 v57, v2, 4, 1
    v_and_b32 v58, 3, v2
    v_lshlrev_b32 v59, 3, v4
    v_add_u32 v59, v59, v56
    v_lshlrev_b32 v59, 8, v59
    v_lshlrev_b32 v60, 5, v57
    v_add_u32 v59, v59, v60
    v_and_b32 v60, 1, v58
    v_lshlrev_b32 v60, 4, v60
    v_add_u32 v59, v59, v60
    v_lshrrev_b32 v60, 1, v58
    v_lshlrev_b32 v60, 3, v60
    v_add_u32 v59, v59, v60
    v_xor_b32 v60, 0, v56
    v_lshlrev_b32 v60, 6, v60
    v_add_u32 v32, v59, v60
    v_xor_b32 v60, 1, v56
    v_lshlrev_b32 v60, 6, v60
    v_add_u32 v33, v59, v60
    v_xor_b32 v60, 2, v56
    v_lshlrev_b32 v60, 6, v60
    v_add_u32 v34, v59, v60
    v_xor_b32 v60, 3, v56
    v_lshlrev_b32 v60, 6, v60
    v_add_u32 v35, v59, v60
    v_bfe_u32 v56, v2, 2, 2
    v_bfe_u32 v57, v2, 4, 1
    v_and_b32 v58, 3, v2
    v_lshlrev_b32 v59, 2, v4
    v_add_u32 v59, v59, v56
    v_lshlrev_b32 v59, 8, v59
    v_lshlrev_b32 v60, 5, v57
    v_add_u32 v59, v59, v60
    v_lshlrev_b32 v60, 3, v58
    v_add_u32 v59, v59, v60
    v_xor_b32 v60, 0, v56
    v_lshlrev_b32 v60, 6, v60
    v_add_u32 v28, v59, v60
    v_xor_b32 v60, 1, v56
    v_lshlrev_b32 v60, 6, v60
    v_add_u32 v29, v59, v60
    v_xor_b32 v60, 2, v56
    v_lshlrev_b32 v60, 6, v60
    v_add_u32 v30, v59, v60
    v_xor_b32 v60, 3, v56
    v_lshlrev_b32 v60, 6, v60
    v_add_u32 v31, v59, v60
    v_mov_b32 v40, v32
    s_cmp_eq_u32 s24, 1
    s_cbranch_scc0 Q_sel1
    v_mov_b32 v40, v33
Q_sel1:
    s_cmp_eq_u32 s24, 2
    s_cbranch_scc0 Q_sel2
    v_mov_b32 v40, v34
Q_sel2:
    s_cmp_eq_u32 s24, 3
    s_cbranch_scc0 Q_sel3
    v_mov_b32 v40, v35
Q_sel3:
    v_and_b32 v8, 3, v2
    v_lshlrev_b32 v8, 7, v8
    v_bfe_u32 v9, v2, 2, 2
    v_mov_b32 v7, 0x2830000
    v_cmp_eq_u32 vcc, 1, v9
    v_mov_b32 v16, 0x2800000
    s_nop 1
    v_cndmask_b32 v7, v7, v16, vcc
    v_cmp_eq_u32 vcc, 2, v9
    v_mov_b32 v16, 0x2850000
    s_nop 1
    v_cndmask_b32 v7, v7, v16, vcc
    v_cmp_eq_u32 vcc, 3, v9
    v_mov_b32 v16, 0x2860000
    s_nop 1
    v_cndmask_b32 v7, v7, v16, vcc
    v_add_u32 v8, v7, v8
    s_lshl_b32 s34, s28, 9
    buffer_load_dword v243, v8, s[20:23], s34 offen
    s_lshl_b32 s66, s26, 5
    s_lshl_b32 s36, s25, 2
    s_add_u32 s66, s66, s36
    s_add_u32 s66, s66, s27
    s_lshl_b32 s66, s66, 14
    s_lshl_b32 s36, s24, 12
    s_add_u32 s66, s66, s36
    v_lshlrev_b32 v8, 6, v2
    s_add_u32 s67, s66, 0x400000
    buffer_load_dword v62, v8, s[20:23], s66 offen
    s_getpc_b64 s[34:35]
F_pc:
    s_sub_u32 s34, s34, F_pc-F_begin
    s_subb_u32 s35, s35, 0
    s_lshr_b32 s36, s2, 3
    s_lshl_b32 s36, s36, 10
    v_and_b32 v8, 7, v2
    v_lshlrev_b32 v8, 7, v8
    v_add_u32 v8, s36, v8
    global_load_dword v63, v8, s[34:35]
    s_waitcnt vmcnt(15)
    s_barrier
    ds_read_b64_tr_b16 a[0:1], v40 offset:16384
    ds_read_b64_tr_b16 a[2:3], v40 offset:17408
    ds_read_b128 a[32:35], v20
    ds_read_b128 a[36:39], v20 offset:8192
    ds_read_b64_tr_b16 a[4:5], v40 offset:20480
    ds_read_b64_tr_b16 a[6:7], v40 offset:21504
    ds_read_b128 a[40:43], v21
    ds_read_b128 a[44:47], v21 offset:8192
    ds_read_b64_tr_b16 a[8:9], v40 offset:24576
    ds_read_b64_tr_b16 a[10:11], v40 offset:25600
    ds_read_b128 a[48:51], v22
    ds_read_b128 a[52:55], v22 offset:8192
    s_waitcnt lgkmcnt(8)
    v_mfma_f32_32x32x16_bf16 v[64:79], a[0:3], a[32:35], 0
    ds_read_b64_tr_b16 a[12:13], v40 offset:28672
    ds_read_b64_tr_b16 a[14:15], v40 offset:29696
    ds_read_b128 a[56:59], v23
    ds_read_b128 a[60:63], v23 offset:8192
    v_mfma_f32_32x32x16_bf16 v[80:95], a[0:3], a[36:39], 0
    s_add_u32 s34, s33, 2
    s_and_b32 s34, s34, 3
    s_lshl_b32 s35, s34, 8
    s_lshl_b32 s36, s24, 14
    s_add_u32 s35, s35, s36
    s_lshl_b32 s36, s24, 12
    s_add_u32 m0, s36, 98304
    s_add_u32 s31, s35, 0
    buffer_load_dwordx4 v44, s[40:43], s31 offen lds
    s_waitcnt lgkmcnt(8)
    v_mfma_f32_32x32x16_bf16 v[64:79], a[4:7], a[40:43], v[64:79]
    ds_read_b64_tr_b16 a[16:17], v40 offset:32768
    ds_read_b64_tr_b16 a[18:19], v40 offset:33792
    ds_read_b128 a[64:67], v24
    ds_read_b128 a[68:71], v24 offset:8192
    v_mfma_f32_32x32x16_bf16 v[80:95], a[4:7], a[44:47], v[80:95]
    s_add_u32 m0, s36, 99328
    s_add_u32 s31, s35, 4096
    buffer_load_dwordx4 v45, s[40:43], s31 offen lds
    s_waitcnt lgkmcnt(8)
    v_mfma_f32_32x32x16_bf16 v[64:79], a[8:11], a[48:51], v[64:79]
    ds_read_b64_tr_b16 a[20:21], v40 offset:36864
    ds_read_b64_tr_b16 a[22:23], v40 offset:37888
    ds_read_b128 a[72:75], v25
    ds_read_b128 a[76:79], v25 offset:8192
    v_mfma_f32_32x32x16_bf16 v[80:95], a[8:11], a[52:55], v[80:95]
    s_add_u32 m0, s36, 100352
    s_add_u32 s31, s35, 8192
    buffer_load_dwordx4 v46, s[40:43], s31 offen lds
    s_waitcnt lgkmcnt(8)
    v_mfma_f32_32x32x16_bf16 v[64:79], a[12:15], a[56:59], v[64:79]
    ds_read_b64_tr_b16 a[24:25], v40 offset:40960
    ds_read_b64_tr_b16 a[26:27], v40 offset:41984
    ds_read_b128 a[80:83], v26
    ds_read_b128 a[84:87], v26 offset:8192
    v_mfma_f32_32x32x16_bf16 v[80:95], a[12:15], a[60:63], v[80:95]
    s_add_u32 m0, s36, 101376
    s_add_u32 s31, s35, 12288
    buffer_load_dwordx4 v47, s[40:43], s31 offen lds
    s_waitcnt lgkmcnt(8)
    v_mfma_f32_32x32x16_bf16 v[64:79], a[16:19], a[64:67], v[64:79]
    ds_read_b64_tr_b16 a[28:29], v40 offset:45056
    ds_read_b64_tr_b16 a[30:31], v40 offset:46080
    ds_read_b128 a[88:91], v27
    ds_read_b128 a[92:95], v27 offset:8192
    v_mfma_f32_32x32x16_bf16 v[80:95], a[16:19], a[68:71], v[80:95]
    s_lshl_b32 s35, s34, 20
    s_lshl_b32 s36, s24, 18
    s_add_u32 s35, s35, s36
    s_lshl_b32 s36, s24, 13
    s_add_u32 m0, s36, 114688
    s_add_u32 s31, s35, 0
    buffer_load_dwordx4 v48, s[44:47], s31 offen lds
    s_add_u32 m0, s36, 115712
    s_add_u32 s31, s35, 32768
    buffer_load_dwordx4 v48, s[44:47], s31 offen lds
    s_waitcnt lgkmcnt(8)
    v_mfma_f32_32x32x16_bf16 v[64:79], a[20:23], a[72:75], v[64:79]
    v_mfma_f32_32x32x16_bf16 v[80:95], a[20:23], a[76:79], v[80:95]
    s_add_u32 m0, s36, 116736
    s_add_u32 s31, s35, 65536
    buffer_load_dwordx4 v48, s[44:47], s31 offen lds
    s_add_u32 m0, s36, 117760
    s_add_u32 s31, s35, 98304
    buffer_load_dwordx4 v48, s[44:47], s31 offen lds
    s_waitcnt lgkmcnt(4)
    v_mfma_f32_32x32x16_bf16 v[64:79], a[24:27], a[80:83], v[64:79]
    v_mfma_f32_32x32x16_bf16 v[80:95], a[24:27], a[84:87], v[80:95]
    s_add_u32 m0, s36, 118784
    s_add_u32 s31, s35, 131072
    buffer_load_dwordx4 v48, s[44:47], s31 offen lds
    s_add_u32 m0, s36, 119808
    s_add_u32 s31, s35, 163840
    buffer_load_dwordx4 v48, s[44:47], s31 offen lds
    s_waitcnt lgkmcnt(0)
    v_mfma_f32_32x32x16_bf16 v[64:79], a[28:31], a[88:91], v[64:79]
    v_mfma_f32_32x32x16_bf16 v[80:95], a[28:31], a[92:95], v[80:95]
    s_add_u32 m0, s36, 120832
    s_add_u32 s31, s35, 196608
    buffer_load_dwordx4 v48, s[44:47], s31 offen lds
    s_add_u32 m0, s36, 121856
    s_add_u32 s31, s35, 229376
    buffer_load_dwordx4 v48, s[44:47], s31 offen lds
    v_add_u32 v41, 49152, v40
    v_add_u32 v50, 49152, v20
    v_add_u32 v51, 49152, v21
    v_add_u32 v52, 49152, v22
    v_add_u32 v53, 49152, v23
    v_add_u32 v54, 49152, v24
    v_add_u32 v55, 49152, v25
    v_add_u32 v56, 49152, v26
    v_add_u32 v57, 49152, v27
    s_waitcnt vmcnt(15)
    s_barrier
    ds_read_b64_tr_b16 a[0:1], v41 offset:16384
    ds_read_b64_tr_b16 a[2:3], v41 offset:17408
    ds_read_b128 a[32:35], v50
    ds_read_b128 a[36:39], v50 offset:8192
    ds_read_b64_tr_b16 a[4:5], v41 offset:20480
    ds_read_b64_tr_b16 a[6:7], v41 offset:21504
    ds_read_b128 a[40:43], v51
    ds_read_b128 a[44:47], v51 offset:8192
    ds_read_b64_tr_b16 a[8:9], v41 offset:24576
    ds_read_b64_tr_b16 a[10:11], v41 offset:25600
    ds_read_b128 a[48:51], v52
    ds_read_b128 a[52:55], v52 offset:8192
    s_waitcnt lgkmcnt(8)
    v_mfma_f32_32x32x16_bf16 v[64:79], a[0:3], a[32:35], v[64:79]
    ds_read_b64_tr_b16 a[12:13], v41 offset:28672
    ds_read_b64_tr_b16 a[14:15], v41 offset:29696
    ds_read_b128 a[56:59], v53
    ds_read_b128 a[60:63], v53 offset:8192
    v_mfma_f32_32x32x16_bf16 v[80:95], a[0:3], a[36:39], v[80:95]
    s_add_u32 s34, s33, 3
    s_and_b32 s34, s34, 3
    s_lshl_b32 s35, s34, 8
    s_lshl_b32 s36, s24, 14
    s_add_u32 s35, s35, s36
    s_lshl_b32 s36, s24, 12
    s_add_u32 m0, s36, 0
    s_add_u32 s31, s35, 0
    buffer_load_dwordx4 v44, s[40:43], s31 offen lds
    s_waitcnt lgkmcnt(8)
    v_mfma_f32_32x32x16_bf16 v[64:79], a[4:7], a[40:43], v[64:79]
    ds_read_b64_tr_b16 a[16:17], v41 offset:32768
    ds_read_b64_tr_b16 a[18:19], v41 offset:33792
    ds_read_b128 a[64:67], v54
    ds_read_b128 a[68:71], v54 offset:8192
    v_mfma_f32_32x32x16_bf16 v[80:95], a[4:7], a[44:47], v[80:95]
    s_add_u32 m0, s36, 1024
    s_add_u32 s31, s35, 4096
    buffer_load_dwordx4 v45, s[40:43], s31 offen lds
    s_waitcnt lgkmcnt(8)
    v_mfma_f32_32x32x16_bf16 v[64:79], a[8:11], a[48:51], v[64:79]
    ds_read_b64_tr_b16 a[20:21], v41 offset:36864
    ds_read_b64_tr_b16 a[22:23], v41 offset:37888
    ds_read_b128 a[72:75], v55
    ds_read_b128 a[76:79], v55 offset:8192
    v_mfma_f32_32x32x16_bf16 v[80:95], a[8:11], a[52:55], v[80:95]
    s_add_u32 m0, s36, 2048
    s_add_u32 s31, s35, 8192
    buffer_load_dwordx4 v46, s[40:43], s31 offen lds
    s_waitcnt lgkmcnt(8)
    v_mfma_f32_32x32x16_bf16 v[64:79], a[12:15], a[56:59], v[64:79]
    ds_read_b64_tr_b16 a[24:25], v41 offset:40960
    ds_read_b64_tr_b16 a[26:27], v41 offset:41984
    ds_read_b128 a[80:83], v56
    ds_read_b128 a[84:87], v56 offset:8192
    v_mfma_f32_32x32x16_bf16 v[80:95], a[12:15], a[60:63], v[80:95]
    s_add_u32 m0, s36, 3072
    s_add_u32 s31, s35, 12288
    buffer_load_dwordx4 v47, s[40:43], s31 offen lds
    s_waitcnt lgkmcnt(8)
    v_mfma_f32_32x32x16_bf16 v[64:79], a[16:19], a[64:67], v[64:79]
    ds_read_b64_tr_b16 a[28:29], v41 offset:45056
    ds_read_b64_tr_b16 a[30:31], v41 offset:46080
    ds_read_b128 a[88:91], v57
    ds_read_b128 a[92:95], v57 offset:8192
    v_mfma_f32_32x32x16_bf16 v[80:95], a[16:19], a[68:71], v[80:95]
    s_lshl_b32 s35, s34, 20
    s_lshl_b32 s36, s24, 18
    s_add_u32 s35, s35, s36
    s_lshl_b32 s36, s24, 13
    s_add_u32 m0, s36, 16384
    s_add_u32 s31, s35, 0
    buffer_load_dwordx4 v48, s[44:47], s31 offen lds
    s_add_u32 m0, s36, 17408
    s_add_u32 s31, s35, 32768
    buffer_load_dwordx4 v48, s[44:47], s31 offen lds
    s_waitcnt lgkmcnt(8)
    v_mfma_f32_32x32x16_bf16 v[64:79], a[20:23], a[72:75], v[64:79]
    v_mfma_f32_32x32x16_bf16 v[80:95], a[20:23], a[76:79], v[80:95]
    s_add_u32 m0, s36, 18432
    s_add_u32 s31, s35, 65536
    buffer_load_dwordx4 v48, s[44:47], s31 offen lds
    s_add_u32 m0, s36, 19456
    s_add_u32 s31, s35, 98304
    buffer_load_dwordx4 v48, s[44:47], s31 offen lds
    s_waitcnt lgkmcnt(4)
    v_mfma_f32_32x32x16_bf16 v[64:79], a[24:27], a[80:83], v[64:79]
    v_mfma_f32_32x32x16_bf16 v[80:95], a[24:27], a[84:87], v[80:95]
    s_add_u32 m0, s36, 20480
    s_add_u32 s31, s35, 131072
    buffer_load_dwordx4 v48, s[44:47], s31 offen lds
    s_add_u32 m0, s36, 21504
    s_add_u32 s31, s35, 163840
    buffer_load_dwordx4 v48, s[44:47], s31 offen lds
    s_waitcnt lgkmcnt(0)
    v_mfma_f32_32x32x16_bf16 v[64:79], a[28:31], a[88:91], v[64:79]
    v_mfma_f32_32x32x16_bf16 v[80:95], a[28:31], a[92:95], v[80:95]
    s_add_u32 m0, s36, 22528
    s_add_u32 s31, s35, 196608
    buffer_load_dwordx4 v48, s[44:47], s31 offen lds
    s_add_u32 m0, s36, 23552
    s_add_u32 s31, s35, 229376
    buffer_load_dwordx4 v48, s[44:47], s31 offen lds
    v_add_u32 v41, 98304, v40
    v_add_u32 v50, 98304, v20
    v_add_u32 v51, 98304, v21
    v_add_u32 v52, 98304, v22
    v_add_u32 v53, 98304, v23
    v_add_u32 v54, 98304, v24
    v_add_u32 v55, 98304, v25
    v_add_u32 v56, 98304, v26
    v_add_u32 v57, 98304, v27
    s_waitcnt vmcnt(12)
    s_barrier
    ds_read_b64_tr_b16 a[0:1], v41 offset:16384
    ds_read_b64_tr_b16 a[2:3], v41 offset:17408
    ds_read_b128 a[32:35], v50
    ds_read_b128 a[36:39], v50 offset:8192
    ds_read_b64_tr_b16 a[4:5], v41 offset:20480
    ds_read_b64_tr_b16 a[6:7], v41 offset:21504
    ds_read_b128 a[40:43], v51
    ds_read_b128 a[44:47], v51 offset:8192
    ds_read_b64_tr_b16 a[8:9], v41 offset:24576
    ds_read_b64_tr_b16 a[10:11], v41 offset:25600
    ds_read_b128 a[48:51], v52
    ds_read_b128 a[52:55], v52 offset:8192
    s_waitcnt lgkmcnt(8)
    v_mfma_f32_32x32x16_bf16 v[64:79], a[0:3], a[32:35], v[64:79]
    ds_read_b64_tr_b16 a[12:13], v41 offset:28672
    ds_read_b64_tr_b16 a[14:15], v41 offset:29696
    ds_read_b128 a[56:59], v53
    ds_read_b128 a[60:63], v53 offset:8192
    v_mfma_f32_32x32x16_bf16 v[80:95], a[0:3], a[36:39], v[80:95]
    s_lshl_b32 s34, s26, 5
    s_add_u32 s34, s34, s25
    s_lshl_b32 s34, s34, 7
    s_add_u32 s34, s34, 0x2820000
    v_and_b32 v8, 3, v2
    v_lshlrev_b32 v8, 10, v8
    buffer_load_dwordx4 v[16:19], v8, s[20:23], s34 offen sc1
    s_waitcnt lgkmcnt(8)
    v_mfma_f32_32x32x16_bf16 v[64:79], a[4:7], a[40:43], v[64:79]
    ds_read_b64_tr_b16 a[16:17], v41 offset:32768
    ds_read_b64_tr_b16 a[18:19], v41 offset:33792
    ds_read_b128 a[64:67], v54
    ds_read_b128 a[68:71], v54 offset:8192
    v_mfma_f32_32x32x16_bf16 v[80:95], a[4:7], a[44:47], v[80:95]
    v_mov_b32 v7, 0
    global_load_dwordx2 v[14:15], v7, s[60:61] sc1
    s_waitcnt lgkmcnt(8)
    v_mfma_f32_32x32x16_bf16 v[64:79], a[8:11], a[48:51], v[64:79]
    ds_read_b64_tr_b16 a[20:21], v41 offset:36864
    ds_read_b64_tr_b16 a[22:23], v41 offset:37888
    ds_read_b128 a[72:75], v55
    ds_read_b128 a[76:79], v55 offset:8192
    v_mfma_f32_32x32x16_bf16 v[80:95], a[8:11], a[52:55], v[80:95]
    s_add_u32 m0, s30, 49152
    s_add_u32 s31, s29, 0
    buffer_load_dwordx4 v10, s[12:15], s31 offen nt lds
    s_waitcnt lgkmcnt(8)
    v_mfma_f32_32x32x16_bf16 v[64:79], a[12:15], a[56:59], v[64:79]
    ds_read_b64_tr_b16 a[24:25], v41 offset:40960
    ds_read_b64_tr_b16 a[26:27], v41 offset:41984
    ds_read_b128 a[80:83], v56
    ds_read_b128 a[84:87], v56 offset:8192
    v_mfma_f32_32x32x16_bf16 v[80:95], a[12:15], a[60:63], v[80:95]
    buffer_load_dwordx4 v11, s[12:15], s31 offen offset:1024 nt lds
    s_waitcnt lgkmcnt(8)
    v_mfma_f32_32x32x16_bf16 v[64:79], a[16:19], a[64:67], v[64:79]
    ds_read_b64_tr_b16 a[28:29], v41 offset:45056
    ds_read_b64_tr_b16 a[30:31], v41 offset:46080
    ds_read_b128 a[88:91], v57
    ds_read_b128 a[92:95], v57 offset:8192
    v_mfma_f32_32x32x16_bf16 v[80:95], a[16:19], a[68:71], v[80:95]
    s_add_u32 m0, s30, 57344
    s_nop 0
    buffer_load_dwordx4 v12, s[16:19], s31 offen nt lds
    s_waitcnt lgkmcnt(8)
    v_mfma_f32_32x32x16_bf16 v[64:79], a[20:23], a[72:75], v[64:79]
    v_mfma_f32_32x32x16_bf16 v[80:95], a[20:23], a[76:79], v[80:95]
    buffer_load_dwordx4 v12, s[16:19], s31 offen offset:1024 nt lds
    s_waitcnt lgkmcnt(4)
    v_mfma_f32_32x32x16_bf16 v[64:79], a[24:27], a[80:83], v[64:79]
    v_mfma_f32_32x32x16_bf16 v[80:95], a[24:27], a[84:87], v[80:95]
    s_waitcnt lgkmcnt(0)
    v_mfma_f32_32x32x16_bf16 v[64:79], a[28:31], a[88:91], v[64:79]
    v_mfma_f32_32x32x16_bf16 v[80:95], a[28:31], a[92:95], v[80:95]
    s_waitcnt vmcnt(6)
    s_barrier
    ds_read_b64_tr_b16 a[0:1], v40 offset:16384
    ds_read_b64_tr_b16 a[2:3], v40 offset:17408
    ds_read_b128 a[32:35], v20
    ds_read_b128 a[36:39], v20 offset:8192
    ds_read_b64_tr_b16 a[4:5], v40 offset:20480
    ds_read_b64_tr_b16 a[6:7], v40 offset:21504
    ds_read_b128 a[40:43], v21
    ds_read_b128 a[44:47], v21 offset:8192
    ds_read_b64_tr_b16 a[8:9], v40 offset:24576
    ds_read_b64_tr_b16 a[10:11], v40 offset:25600
    ds_read_b128 a[48:51], v22
    ds_read_b128 a[52:55], v22 offset:8192
    s_waitcnt lgkmcnt(8)
    v_mfma_f32_32x32x16_bf16 v[64:79], a[0:3], a[32:35], v[64:79]
    ds_read_b64_tr_b16 a[12:13], v40 offset:28672
    ds_read_b64_tr_b16 a[14:15], v40 offset:29696
    ds_read_b128 a[56:59], v23
    ds_read_b128 a[60:63], v23 offset:8192
    v_mfma_f32_32x32x16_bf16 v[80:95], a[0:3], a[36:39], v[80:95]
    s_waitcnt lgkmcnt(8)
    v_mfma_f32_32x32x16_bf16 v[64:79], a[4:7], a[40:43], v[64:79]
    ds_read_b64_tr_b16 a[16:17], v40 offset:32768
    ds_read_b64_tr_b16 a[18:19], v40 offset:33792
    ds_read_b128 a[64:67], v24
    ds_read_b128 a[68:71], v24 offset:8192
    v_mfma_f32_32x32x16_bf16 v[80:95], a[4:7], a[44:47], v[80:95]
    s_waitcnt lgkmcnt(8)
    v_mfma_f32_32x32x16_bf16 v[64:79], a[8:11], a[48:51], v[64:79]
    ds_read_b64_tr_b16 a[20:21], v40 offset:36864
    ds_read_b64_tr_b16 a[22:23], v40 offset:37888
    ds_read_b128 a[72:75], v25
    ds_read_b128 a[76:79], v25 offset:8192
    v_mfma_f32_32x32x16_bf16 v[80:95], a[8:11], a[52:55], v[80:95]
    s_waitcnt lgkmcnt(8)
    v_mfma_f32_32x32x16_bf16 v[64:79], a[12:15], a[56:59], v[64:79]
    ds_read_b64_tr_b16 a[24:25], v40 offset:40960
    ds_read_b64_tr_b16 a[26:27], v40 offset:41984
    ds_read_b128 a[80:83], v26
    ds_read_b128 a[84:87], v26 offset:8192
    v_mfma_f32_32x32x16_bf16 v[80:95], a[12:15], a[60:63], v[80:95]
    s_waitcnt lgkmcnt(8)
    v_mfma_f32_32x32x16_bf16 v[64:79], a[16:19], a[64:67], v[64:79]
    ds_read_b64_tr_b16 a[28:29], v40 offset:45056
    ds_read_b64_tr_b16 a[30:31], v40 offset:46080
    ds_read_b128 a[88:91], v27
    ds_read_b128 a[92:95], v27 offset:8192
    v_mfma_f32_32x32x16_bf16 v[80:95], a[16:19], a[68:71], v[80:95]
    s_waitcnt lgkmcnt(8)
    v_mfma_f32_32x32x16_bf16 v[64:79], a[20:23], a[72:75], v[64:79]
    v_mfma_f32_32x32x16_bf16 v[80:95], a[20:23], a[76:79], v[80:95]
    s_waitcnt lgkmcnt(4)
    v_mfma_f32_32x32x16_bf16 v[64:79], a[24:27], a[80:83], v[64:79]
    v_mfma_f32_32x32x16_bf16 v[80:95], a[24:27], a[84:87], v[80:95]
    s_waitcnt lgkmcnt(0)
    v_mfma_f32_32x32x16_bf16 v[64:79], a[28:31], a[88:91], v[64:79]
    v_mfma_f32_32x32x16_bf16 v[80:95], a[28:31], a[92:95], v[80:95]
    s_memrealtime s[34:35]
    s_mov_b32 s36, 0x3e0293ee
    s_nop 7
    s_nop 3
    v_mul_f32 v64, s36, v64
    v_mul_f32 v65, s36, v65
    v_mul_f32 v66, s36, v66
    v_mul_f32 v67, s36, v67
    v_mul_f32 v68, s36, v68
    v_mul_f32 v69, s36, v69
    v_mul_f32 v70, s36, v70
    v_mul_f32 v71, s36, v71
    v_mul_f32 v72, s36, v72
    v_mul_f32 v73, s36, v73
    v_mul_f32 v74, s36, v74
    v_mul_f32 v75, s36, v75
    v_mul_f32 v76, s36, v76
    v_mul_f32 v77, s36, v77
    v_mul_f32 v78, s36, v78
    v_mul_f32 v79, s36, v79
    v_mul_f32 v80, s36, v80
    v_mul_f32 v81, s36, v81
    v_mul_f32 v82, s36, v82
    v_mul_f32 v83, s36, v83
    v_mul_f32 v84, s36, v84
    v_mul_f32 v85, s36, v85
    v_mul_f32 v86, s36, v86
    v_mul_f32 v87, s36, v87
    v_mul_f32 v88, s36, v88
    v_mul_f32 v89, s36, v89
    v_mul_f32 v90, s36, v90
    v_mul_f32 v91, s36, v91
    v_mul_f32 v92, s36, v92
    v_mul_f32 v93, s36, v93
    v_mul_f32 v94, s36, v94
    v_mul_f32 v95, s36, v95
    v_cvt_pk_bf16_f32 v112, v64, v65
    v_cvt_pk_bf16_f32 v113, v66, v67
    v_cvt_pk_bf16_f32 v114, v68, v69
    v_cvt_pk_bf16_f32 v115, v70, v71
    v_cvt_pk_bf16_f32 v116, v72, v73
    v_cvt_pk_bf16_f32 v117, v74, v75
    v_cvt_pk_bf16_f32 v118, v76, v77
    v_cvt_pk_bf16_f32 v119, v78, v79
    v_cvt_pk_bf16_f32 v120, v80, v81
    v_cvt_pk_bf16_f32 v121, v82, v83
    v_cvt_pk_bf16_f32 v122, v84, v85
    v_cvt_pk_bf16_f32 v123, v86, v87
    v_cvt_pk_bf16_f32 v124, v88, v89
    v_cvt_pk_bf16_f32 v125, v90, v91
    v_cvt_pk_bf16_f32 v126, v92, v93
    v_cvt_pk_bf16_f32 v127, v94, v95
    s_waitcnt vmcnt(4)
    s_waitcnt lgkmcnt(0)
    v_sub_u32 v8, s34, v16
    v_cmp_gt_u32 vcc, 800, v8
    v_cmp_eq_u32 s[46:47], s35, v17
    s_nop 1
    s_and_b64 vcc, vcc, s[46:47]
    v_cmp_eq_u32 s[46:47], s37, v18
    s_nop 1
    s_and_b64 vcc, vcc, s[46:47]
    s_cmp_eq_u64 vcc, -1
    s_cselect_b32 s68, 1, 0
    v_readfirstlane_b32 s38, v14
    v_readfirstlane_b32 s39, v15
    s_cmp_lg_u32 s68, 0
    s_cbranch_scc1 F_qst_f
    buffer_store_dwordx4 v[112:115], v13, s[20:23], s66 offen offset:0 sc1
    buffer_store_dwordx4 v[116:119], v13, s[20:23], s66 offen offset:2048 sc1
    buffer_store_dwordx4 v[120:123], v13, s[20:23], s66 offen offset:1024 sc1
    buffer_store_dwordx4 v[124:127], v13, s[20:23], s66 offen offset:3072 sc1
    s_branch F_qst_d
F_qst_f:
    buffer_store_dwordx4 v[112:115], v13, s[20:23], s66 offen offset:0 nt
    buffer_store_dwordx4 v[116:119], v13, s[20:23], s66 offen offset:2048 nt
    buffer_store_dwordx4 v[120:123], v13, s[20:23], s66 offen offset:1024 nt
    buffer_store_dwordx4 v[124:127], v13, s[20:23], s66 offen offset:3072 nt
F_qst_d:
    s_cmp_eq_u32 s24, 0
    s_cbranch_scc1 F_x0_w0
    s_waitcnt vmcnt(0)
    s_barrier
    s_add_u32 m0, s30, 65536
    s_add_u32 s31, s29, 8192
    buffer_load_dwordx4 v10, s[12:15], s31 offen nt lds
    buffer_load_dwordx4 v11, s[12:15], s31 offen offset:1024 nt lds
    s_add_u32 m0, s30, 73728
    s_nop 0
    buffer_load_dwordx4 v12, s[16:19], s31 offen nt lds
    buffer_load_dwordx4 v12, s[16:19], s31 offen offset:1024 nt lds
    s_branch F_x0_join
F_x0_w0:
    s_waitcnt vmcnt(0)
    s_cmp_lg_u32 s38, 0
    s_cbranch_scc1 F_nonce_ok
    v_mov_b32 v7, 0
    s_mov_b32 s44, 0
F_rdnonce:
    global_load_dwordx2 v[8:9], v7, s[60:61] sc1
    s_waitcnt vmcnt(0)
    v_readfirstlane_b32 s38, v8
    v_readfirstlane_b32 s39, v9
    s_add_u32 s44, s44, 1
    s_cmp_lg_u32 s38, 0
    s_cbranch_scc1 F_nonce_ok
    s_cmp_lt_u32 s44, 300000
    s_cbranch_scc1 F_rdnonce
F_nonce_ok:
    s_barrier
    s_add_u32 s52, s64, 0x2830000
    s_addc_u32 s53, s65, 0
    s_lshl_b32 s45, s28, 9
    s_add_u32 s52, s52, s45
    s_addc_u32 s53, s53, 0
    s_lshl_b32 s45, s27, 7
    v_mov_b32 v7, s45
    v_mov_b32 v8, s38
    v_mov_b32 v9, s39
    s_mov_b64 exec, 1
    s_cmp_lg_u32 s68, 0
    s_cbranch_scc1 F_x0_fl_f
    global_store_dwordx2 v7, v[8:9], s[52:53] sc1
    s_branch F_x0_fl_d
F_x0_fl_f:
    global_store_dwordx2 v7, v[8:9], s[52:53]
F_x0_fl_d:
    s_mov_b64 exec, -1
    v_and_b32 v7, 3, v2
    v_lshlrev_b32 v7, 7, v7
    s_add_u32 m0, s30, 65536
    s_add_u32 s31, s29, 8192
    buffer_load_dwordx4 v10, s[12:15], s31 offen nt lds
    buffer_load_dwordx4 v11, s[12:15], s31 offen offset:1024 nt lds
    s_add_u32 m0, s30, 73728
    s_nop 0
    buffer_load_dwordx4 v12, s[16:19], s31 offen nt lds
    buffer_load_dwordx4 v12, s[16:19], s31 offen offset:1024 nt lds
    s_mov_b32 s44, 0
F_x0_poll:
    global_load_dwordx2 v[8:9], v7, s[52:53] sc1
    s_waitcnt vmcnt(0)
    v_cmp_eq_u32 vcc, s38, v8
    v_cmp_eq_u32 s[46:47], s39, v9
    s_add_u32 s44, s44, 1
    s_nop 2
    s_and_b64 vcc, vcc, s[46:47]
    s_cmp_eq_u64 vcc, -1
    s_cbranch_scc1 F_x0_poll_ok
    s_cmp_lt_u32 s44, 300000
    s_cbranch_scc1 F_x0_poll
F_x0_poll_ok:
F_x0_join:
    s_barrier
    s_lshl_b32 s35, s26, 5
    s_lshl_b32 s36, s25, 2
    s_add_u32 s35, s35, s36
    s_add_u32 s35, s35, s24
    s_lshl_b32 s35, s35, 14
    buffer_load_dwordx4 a[128:131], v13, s[20:23], s35 offen offset:0 sc1
    buffer_load_dwordx4 a[132:135], v13, s[20:23], s35 offen offset:1024 sc1
    buffer_load_dwordx4 a[136:139], v13, s[20:23], s35 offen offset:2048 sc1
    buffer_load_dwordx4 a[140:143], v13, s[20:23], s35 offen offset:3072 sc1
    s_add_u32 s35, s35, 4096
    buffer_load_dwordx4 a[144:147], v13, s[20:23], s35 offen offset:0 sc1
    buffer_load_dwordx4 a[148:151], v13, s[20:23], s35 offen offset:1024 sc1
    buffer_load_dwordx4 a[152:155], v13, s[20:23], s35 offen offset:2048 sc1
    buffer_load_dwordx4 a[156:159], v13, s[20:23], s35 offen offset:3072 sc1
    s_add_u32 s35, s35, 4096
    buffer_load_dwordx4 a[160:163], v13, s[20:23], s35 offen offset:0 sc1
    buffer_load_dwordx4 a[164:167], v13, s[20:23], s35 offen offset:1024 sc1
    buffer_load_dwordx4 a[168:171], v13, s[20:23], s35 offen offset:2048 sc1
    buffer_load_dwordx4 a[172:175], v13, s[20:23], s35 offen offset:3072 sc1
    s_add_u32 s35, s35, 4096
    buffer_load_dwordx4 a[176:179], v13, s[20:23], s35 offen offset:0 sc1
    buffer_load_dwordx4 a[180:183], v13, s[20:23], s35 offen offset:1024 sc1
    buffer_load_dwordx4 a[184:187], v13, s[20:23], s35 offen offset:2048 sc1
    buffer_load_dwordx4 a[188:191], v13, s[20:23], s35 offen offset:3072 sc1
    s_add_u32 m0, s30, 81920
    s_add_u32 s31, s29, 16384
    buffer_load_dwordx4 v10, s[12:15], s31 offen nt lds
    buffer_load_dwordx4 v11, s[12:15], s31 offen offset:1024 nt lds
    s_add_u32 m0, s30, 90112
    s_nop 0
    buffer_load_dwordx4 v12, s[16:19], s31 offen nt lds
    buffer_load_dwordx4 v12, s[16:19], s31 offen offset:1024 nt lds
    s_add_u32 m0, s30, 98304
    s_add_u32 s31, s29, 24576
    buffer_load_dwordx4 v10, s[12:15], s31 offen nt lds
    buffer_load_dwordx4 v11, s[12:15], s31 offen offset:1024 nt lds
    s_add_u32 m0, s30, 106496
    s_nop 0
    buffer_load_dwordx4 v12, s[16:19], s31 offen nt lds
    buffer_load_dwordx4 v12, s[16:19], s31 offen offset:1024 nt lds
    v_and_b32 v8, 15, v2
    v_xor_b32 v8, v8, v4
    v_lshlrev_b32 v8, 4, v8
    v_and_b32 v9, 31, v2
    v_lshlrev_b32 v9, 8, v9
    v_add_u32 v8, v8, v9
    v_xor_b32 v16, 0, v8
    v_xor_b32 v17, 32, v8
    v_xor_b32 v18, 64, v8
    v_xor_b32 v19, 96, v8
    v_xor_b32 v20, 128, v8
    v_xor_b32 v21, 160, v8
    v_xor_b32 v22, 192, v8
    v_xor_b32 v23, 224, v8
    v_bfe_u32 v56, v2, 2, 2
    v_bfe_u32 v57, v2, 4, 1
    v_and_b32 v58, 3, v2
    v_lshlrev_b32 v59, 2, v4
    v_add_u32 v59, v59, v56
    v_lshlrev_b32 v59, 8, v59
    v_lshlrev_b32 v60, 5, v57
    v_add_u32 v59, v59, v60
    v_lshlrev_b32 v60, 3, v58
    v_add_u32 v59, v59, v60
    v_xor_b32 v60, 0, v56
    v_lshlrev_b32 v60, 6, v60
    v_add_u32 v32, v59, v60
    v_xor_b32 v60, 1, v56
    v_lshlrev_b32 v60, 6, v60
    v_add_u32 v33, v59, v60
    v_xor_b32 v60, 2, v56
    v_lshlrev_b32 v60, 6, v60
    v_add_u32 v34, v59, v60
    v_xor_b32 v60, 3, v56
    v_lshlrev_b32 v60, 6, v60
    v_add_u32 v35, v59, v60
    v_add_u32 v24, 0x10000, v16
    v_add_u32 v25, 0x10000, v17
    v_add_u32 v26, 0x10000, v18
    v_add_u32 v27, 0x10000, v19
    v_add_u32 v28, 0x10000, v20
    v_add_u32 v29, 0x10000, v21
    v_add_u32 v30, 0x10000, v22
    v_add_u32 v31, 0x10000, v23
    v_add_u32 v36, 0x10000, v32
    v_add_u32 v37, 0x10000, v33
    v_add_u32 v38, 0x10000, v34
    v_add_u32 v39, 0x10000, v35
    v_add_u32 v192, 0x20000, v16
    v_add_u32 v193, 0x20000, v17
    v_add_u32 v194, 0x20000, v18
    v_add_u32 v195, 0x20000, v19
    v_add_u32 v196, 0x20000, v20
    v_add_u32 v197, 0x20000, v21
    v_add_u32 v198, 0x20000, v22
    v_add_u32 v199, 0x20000, v23
    v_add_u32 v200, 0x20000, v32
    v_add_u32 v201, 0x20000, v33
    v_add_u32 v202, 0x20000, v34
    v_add_u32 v203, 0x20000, v35
    v_mov_b32 v52, 0
    v_mov_b32 v53, 0
    v_mov_b32 v205, v49
    s_lshl_b32 s52, s25, 19
    s_lshl_b32 s53, s27, 8
    s_add_u32 s52, s52, s53
    s_lshl_b32 s53, s24, 14
    s_add_u32 s52, s52, s53
    s_lshl_b32 s53, s24, 12
    s_waitcnt vmcnt(8)
    s_barrier
    ds_read_b128 a[192:195], v16 offset:49152
    ds_read_b128 a[196:199], v17 offset:49152
    ds_read_b128 a[200:203], v18 offset:49152
    ds_read_b128 a[204:207], v19 offset:49152
    ds_read_b128 a[208:211], v20 offset:49152
    ds_read_b128 a[212:215], v21 offset:49152
    ds_read_b128 a[216:219], v22 offset:49152
    ds_read_b128 a[220:223], v23 offset:49152
    s_waitcnt lgkmcnt(7)
    v_mfma_f32_32x32x16_bf16 v[64:79], a[192:195], a[128:131], 0
    v_mfma_f32_32x32x16_bf16 v[80:95], a[192:195], a[132:135], 0
    s_waitcnt lgkmcnt(6)
    v_mfma_f32_32x32x16_bf16 v[64:79], a[196:199], a[136:139], v[64:79]
    v_mfma_f32_32x32x16_bf16 v[80:95], a[196:199], a[140:143], v[80:95]
    s_waitcnt lgkmcnt(5)
    v_mfma_f32_32x32x16_bf16 v[64:79], a[200:203], a[144:147], v[64:79]
    v_mfma_f32_32x32x16_bf16 v[80:95], a[200:203], a[148:151], v[80:95]
    s_waitcnt lgkmcnt(4)
    v_mfma_f32_32x32x16_bf16 v[64:79], a[204:207], a[152:155], v[64:79]
    v_mfma_f32_32x32x16_bf16 v[80:95], a[204:207], a[156:159], v[80:95]
    s_waitcnt lgkmcnt(3)
    v_mfma_f32_32x32x16_bf16 v[64:79], a[208:211], a[160:163], v[64:79]
    v_mfma_f32_32x32x16_bf16 v[80:95], a[208:211], a[164:167], v[80:95]
    s_waitcnt lgkmcnt(2)
    v_mfma_f32_32x32x16_bf16 v[64:79], a[212:215], a[168:171], v[64:79]
    v_mfma_f32_32x32x16_bf16 v[80:95], a[212:215], a[172:175], v[80:95]
    s_waitcnt lgkmcnt(1)
    v_mfma_f32_32x32x16_bf16 v[64:79], a[216:219], a[176:179], v[64:79]
    v_mfma_f32_32x32x16_bf16 v[80:95], a[216:219], a[180:183], v[80:95]
    s_waitcnt lgkmcnt(0)
    v_mfma_f32_32x32x16_bf16 v[64:79], a[220:223], a[184:187], v[64:79]
    v_mfma_f32_32x32x16_bf16 v[80:95], a[220:223], a[188:191], v[80:95]
    s_nop 7
    s_nop 7
    v_max3_f32 v54, v64, v65, v66
    v_max3_f32 v54, v54, v67, v68
    v_max3_f32 v54, v54, v69, v70
    v_max3_f32 v54, v54, v71, v72
    v_max3_f32 v54, v54, v73, v74
    v_max3_f32 v54, v54, v75, v76
    v_max3_f32 v54, v54, v77, v78
    v_max_f32 v54, v54, v79
    v_mov_b32 v55, v54
    s_nop 1
    v_permlane32_swap_b32 v54, v55
    s_nop 1
    v_max_f32 v54, v54, v55
    v_sub_f32 v54, 0, v54
    v_mov_b32 v160, v54
    v_mov_b32 v161, v54
    v_mov_b32 v162, v54
    v_mov_b32 v163, v54
    v_mov_b32 v164, v54
    v_mov_b32 v165, v54
    v_mov_b32 v166, v54
    v_mov_b32 v167, v54
    v_mov_b32 v168, v54
    v_mov_b32 v169, v54
    v_mov_b32 v170, v54
    v_mov_b32 v171, v54
    v_mov_b32 v172, v54
    v_mov_b32 v173, v54
    v_mov_b32 v174, v54
    v_mov_b32 v175, v54
    v_add_f32 v64, v64, v54
    v_add_f32 v65, v65, v54
    v_add_f32 v66, v66, v54
    v_add_f32 v67, v67, v54
    v_add_f32 v68, v68, v54
    v_add_f32 v69, v69, v54
    v_add_f32 v70, v70, v54
    v_add_f32 v71, v71, v54
    v_add_f32 v72, v72, v54
    v_add_f32 v73, v73, v54
    v_add_f32 v74, v74, v54
    v_add_f32 v75, v75, v54
    v_add_f32 v76, v76, v54
    v_add_f32 v77, v77, v54
    v_add_f32 v78, v78, v54
    v_add_f32 v79, v79, v54
    v_max3_f32 v54, v80, v81, v82
    v_max3_f32 v54, v54, v83, v84
    v_max3_f32 v54, v54, v85, v86
    v_max3_f32 v54, v54, v87, v88
    v_max3_f32 v54, v54, v89, v90
    v_max3_f32 v54, v54, v91, v92
    v_max3_f32 v54, v54, v93, v94
    v_max_f32 v54, v54, v95
    v_mov_b32 v55, v54
    s_nop 1
    v_permlane32_swap_b32 v54, v55
    s_nop 1
    v_max_f32 v54, v54, v55
    v_sub_f32 v54, 0, v54
    v_mov_b32 v176, v54
    v_mov_b32 v177, v54
    v_mov_b32 v178, v54
    v_mov_b32 v179, v54
    v_mov_b32 v180, v54
    v_mov_b32 v181, v54
    v_mov_b32 v182, v54
    v_mov_b32 v183, v54
    v_mov_b32 v184, v54
    v_mov_b32 v185, v54
    v_mov_b32 v186, v54
    v_mov_b32 v187, v54
    v_mov_b32 v188, v54
    v_mov_b32 v189, v54
    v_mov_b32 v190, v54
    v_mov_b32 v191, v54
    v_add_f32 v80, v80, v54
    v_add_f32 v81, v81, v54
    v_add_f32 v82, v82, v54
    v_add_f32 v83, v83, v54
    v_add_f32 v84, v84, v54
    v_add_f32 v85, v85, v54
    v_add_f32 v86, v86, v54
    v_add_f32 v87, v87, v54
    v_add_f32 v88, v88, v54
    v_add_f32 v89, v89, v54
    v_add_f32 v90, v90, v54
    v_add_f32 v91, v91, v54
    v_add_f32 v92, v92, v54
    v_add_f32 v93, v93, v54
    v_add_f32 v94, v94, v54
    v_add_f32 v95, v95, v54
    s_barrier
    ds_read_b128 a[192:195], v24 offset:0
    ds_read_b128 a[196:199], v25 offset:0
    ds_read_b128 a[200:203], v26 offset:0
    s_waitcnt lgkmcnt(2)
    v_mfma_f32_32x32x16_bf16 v[96:111], a[192:195], a[128:131], v[160:175]
    ds_read_b128 a[204:207], v27 offset:0
    v_exp_f32 v40, v64
    v_exp_f32 v41, v65
    v_mfma_f32_32x32x16_bf16 v[112:127], a[192:195], a[132:135], v[176:191]
    v_exp_f32 v42, v66
    v_pk_add_f32 v[232:233], v[40:41], 0 op_sel_hi:[1,0]
    s_waitcnt lgkmcnt(2)
    v_mfma_f32_32x32x16_bf16 v[96:111], a[196:199], a[136:139], v[96:111]
    ds_read_b128 a[208:211], v28 offset:0
    v_cvt_pk_bf16_f32 v128, v40, v41
    v_exp_f32 v43, v67
    v_mfma_f32_32x32x16_bf16 v[112:127], a[196:199], a[140:143], v[112:127]
    s_add_u32 m0, s30, 114688
    s_add_u32 s31, s29, 32768
    buffer_load_dwordx4 v10, s[12:15], s31 offen nt lds
    s_waitcnt lgkmcnt(2)
    v_mfma_f32_32x32x16_bf16 v[96:111], a[200:203], a[144:147], v[96:111]
    ds_read_b128 a[212:215], v29 offset:0
    v_exp_f32 v44, v68
    v_pk_add_f32 v[232:233], v[232:233], v[42:43]
    v_mfma_f32_32x32x16_bf16 v[112:127], a[200:203], a[148:151], v[112:127]
    v_cvt_pk_bf16_f32 v129, v42, v43
    v_exp_f32 v45, v69
    s_waitcnt lgkmcnt(2)
    v_mfma_f32_32x32x16_bf16 v[96:111], a[204:207], a[152:155], v[96:111]
    ds_read_b128 a[216:219], v30 offset:0
    v_exp_f32 v46, v70
    v_pk_add_f32 v[232:233], v[232:233], v[44:45]
    v_mfma_f32_32x32x16_bf16 v[112:127], a[204:207], a[156:159], v[112:127]
    buffer_load_dwordx4 v11, s[12:15], s31 offen offset:1024 nt lds
    v_cvt_pk_bf16_f32 v130, v44, v45
    v_exp_f32 v47, v71
    s_waitcnt lgkmcnt(2)
    v_mfma_f32_32x32x16_bf16 v[96:111], a[208:211], a[160:163], v[96:111]
    ds_read_b128 a[220:223], v31 offset:0
    v_exp_f32 v40, v72
    v_pk_add_f32 v[232:233], v[232:233], v[46:47]
    v_mfma_f32_32x32x16_bf16 v[112:127], a[208:211], a[164:167], v[112:127]
    v_cvt_pk_bf16_f32 v131, v46, v47
    v_exp_f32 v41, v73
    s_waitcnt lgkmcnt(2)
    v_mfma_f32_32x32x16_bf16 v[96:111], a[212:215], a[168:171], v[96:111]
    ds_read_b64_tr_b16 a[224:225], v32 offset:57344
    ds_read_b64_tr_b16 a[226:227], v32 offset:59392
    v_exp_f32 v42, v74
    v_mfma_f32_32x32x16_bf16 v[112:127], a[212:215], a[172:175], v[112:127]
    s_add_u32 m0, s30, 122880
    s_nop 0
    buffer_load_dwordx4 v12, s[16:19], s31 offen nt lds
    s_waitcnt lgkmcnt(3)
    v_mfma_f32_32x32x16_bf16 v[96:111], a[216:219], a[176:179], v[96:111]
    ds_read_b64_tr_b16 a[228:229], v33 offset:57344
    ds_read_b64_tr_b16 a[230:231], v33 offset:59392
    v_pk_add_f32 v[232:233], v[232:233], v[40:41]
    v_cvt_pk_bf16_f32 v132, v40, v41
    v_mfma_f32_32x32x16_bf16 v[112:127], a[216:219], a[180:183], v[112:127]
    v_exp_f32 v43, v75
    v_exp_f32 v44, v76
    s_waitcnt lgkmcnt(4)
    v_mfma_f32_32x32x16_bf16 v[96:111], a[220:223], a[184:187], v[96:111]
    v_pk_add_f32 v[232:233], v[232:233], v[42:43]
    v_cvt_pk_bf16_f32 v133, v42, v43
    v_exp_f32 v45, v77
    v_mfma_f32_32x32x16_bf16 v[112:127], a[220:223], a[188:191], v[112:127]
    buffer_load_dwordx4 v12, s[16:19], s31 offen offset:1024 nt lds
    v_exp_f32 v46, v78
    v_pk_add_f32 v[232:233], v[232:233], v[44:45]
    v_cvt_pk_bf16_f32 v134, v44, v45
    v_exp_f32 v47, v79
    v_exp_f32 v40, v80
    v_pk_add_f32 v[232:233], v[232:233], v[46:47]
    v_cvt_pk_bf16_f32 v135, v46, v47
    v_exp_f32 v41, v81
    v_exp_f32 v42, v82
    v_pk_add_f32 v[234:235], v[40:41], 0 op_sel_hi:[1,0]
    v_cvt_pk_bf16_f32 v136, v40, v41
    v_exp_f32 v43, v83
    v_exp_f32 v44, v84
    v_pk_add_f32 v[234:235], v[234:235], v[42:43]
    v_cvt_pk_bf16_f32 v137, v42, v43
    v_exp_f32 v45, v85
    v_exp_f32 v46, v86
    v_pk_add_f32 v[234:235], v[234:235], v[44:45]
    v_cvt_pk_bf16_f32 v138, v44, v45
    v_exp_f32 v47, v87
    v_exp_f32 v40, v88
    v_pk_add_f32 v[234:235], v[234:235], v[46:47]
    v_cvt_pk_bf16_f32 v139, v46, v47
    v_exp_f32 v41, v89
    v_exp_f32 v42, v90
    v_pk_add_f32 v[234:235], v[234:235], v[40:41]
    v_cvt_pk_bf16_f32 v140, v40, v41
    v_exp_f32 v43, v91
    v_exp_f32 v44, v92
    v_pk_add_f32 v[234:235], v[234:235], v[42:43]
    v_cvt_pk_bf16_f32 v141, v42, v43
    v_exp_f32 v45, v93
    v_exp_f32 v46, v94
    v_pk_add_f32 v[234:235], v[234:235], v[44:45]
    v_cvt_pk_bf16_f32 v142, v44, v45
    v_exp_f32 v47, v95
    s_nop 0
    v_pk_add_f32 v[234:235], v[234:235], v[46:47]
    v_cvt_pk_bf16_f32 v143, v46, v47
    v_add_f32 v48, v232, v233
    v_add_f32 v49, v234, v235
    v_max_f32 v54, v48, v49
    v_cmp_lt_f32 vcc, s32, v54
    s_cbranch_vccnz F_stub0
F_back0:
    s_waitcnt vmcnt(8)
    s_barrier
    ds_read_b128 a[192:195], v24 offset:16384
    s_waitcnt lgkmcnt(3)
    v_mfma_f32_32x32x16_bf16 a[0:15], a[224:227], v[128:131], 0
    ds_read_b64_tr_b16 a[232:233], v34 offset:57344
    ds_read_b64_tr_b16 a[234:235], v34 offset:59392
    v_add_f32 v52, v52, v48
    v_add_f32 v53, v53, v49
    v_mfma_f32_32x32x16_bf16 a[16:31], a[224:227], v[136:139], 0
    v_exp_f32 v40, v96
    v_exp_f32 v41, v97
    s_waitcnt lgkmcnt(3)
    v_mfma_f32_32x32x16_bf16 a[32:47], a[228:231], v[128:131], 0
    ds_read_b128 a[196:199], v25 offset:16384
    v_exp_f32 v42, v98
    v_pk_add_f32 v[236:237], v[40:41], 0 op_sel_hi:[1,0]
    v_mfma_f32_32x32x16_bf16 a[48:63], a[228:231], v[136:139], 0
    s_add_u32 m0, s30, 131072
    s_add_u32 s31, s29, 40960
    buffer_load_dwordx4 v10, s[12:15], s31 offen nt lds
    v_cvt_pk_bf16_f32 v144, v40, v41
    s_waitcnt lgkmcnt(3)
    v_mfma_f32_32x32x16_bf16 v[64:79], a[192:195], a[128:131], v[160:175]
    ds_read_b64_tr_b16 a[236:237], v35 offset:57344
    ds_read_b64_tr_b16 a[238:239], v35 offset:59392
    v_exp_f32 v43, v99
    v_mfma_f32_32x32x16_bf16 v[80:95], a[192:195], a[132:135], v[176:191]
    v_exp_f32 v44, v100
    v_pk_add_f32 v[236:237], v[236:237], v[42:43]
    s_waitcnt lgkmcnt(3)
    v_mfma_f32_32x32x16_bf16 a[64:79], a[232:235], v[128:131], 0
    ds_read_b128 a[200:203], v26 offset:16384
    v_cvt_pk_bf16_f32 v145, v42, v43
    v_exp_f32 v45, v101
    v_mfma_f32_32x32x16_bf16 a[80:95], a[232:235], v[136:139], 0
    buffer_load_dwordx4 v11, s[12:15], s31 offen offset:1024 nt lds
    v_exp_f32 v46, v102
    s_waitcnt lgkmcnt(3)
    v_mfma_f32_32x32x16_bf16 v[64:79], a[196:199], a[136:139], v[64:79]
    ds_read_b64_tr_b16 a[240:241], v32 offset:61440
    ds_read_b64_tr_b16 a[242:243], v32 offset:63488
    v_pk_add_f32 v[236:237], v[236:237], v[44:45]
    v_cvt_pk_bf16_f32 v146, v44, v45
    v_mfma_f32_32x32x16_bf16 v[80:95], a[196:199], a[140:143], v[80:95]
    v_exp_f32 v47, v103
    v_exp_f32 v40, v104
    s_waitcnt lgkmcnt(3)
    v_mfma_f32_32x32x16_bf16 a[96:111], a[236:239], v[128:131], 0
    ds_read_b128 a[204:207], v27 offset:16384
    v_pk_add_f32 v[236:237], v[236:237], v[46:47]
    v_cvt_pk_bf16_f32 v147, v46, v47
    v_mfma_f32_32x32x16_bf16 a[112:127], a[236:239], v[136:139], 0
    s_add_u32 m0, s30, 139264
    s_nop 0
    buffer_load_dwordx4 v12, s[16:19], s31 offen nt lds
    s_waitcnt lgkmcnt(3)
    v_mfma_f32_32x32x16_bf16 v[64:79], a[200:203], a[144:147], v[64:79]
    ds_read_b64_tr_b16 a[244:245], v33 offset:61440
    ds_read_b64_tr_b16 a[246:247], v33 offset:63488
    v_exp_f32 v41, v105
    v_mfma_f32_32x32x16_bf16 v[80:95], a[200:203], a[148:151], v[80:95]
    v_exp_f32 v42, v106
    v_pk_add_f32 v[236:237], v[236:237], v[40:41]
    s_waitcnt lgkmcnt(3)
    v_mfma_f32_32x32x16_bf16 a[0:15], a[240:243], v[132:135], a[0:15]
    ds_read_b128 a[208:211], v28 offset:16384
    v_cvt_pk_bf16_f32 v148, v40, v41
    v_exp_f32 v43, v107
    v_mfma_f32_32x32x16_bf16 a[16:31], a[240:243], v[140:143], a[16:31]
    buffer_load_dwordx4 v12, s[16:19], s31 offen offset:1024 nt lds
    v_exp_f32 v44, v108
    s_waitcnt lgkmcnt(3)
    v_mfma_f32_32x32x16_bf16 v[64:79], a[204:207], a[152:155], v[64:79]
    ds_read_b64_tr_b16 a[248:249], v34 offset:61440
    ds_read_b64_tr_b16 a[250:251], v34 offset:63488
    v_pk_add_f32 v[236:237], v[236:237], v[42:43]
    v_cvt_pk_bf16_f32 v149, v42, v43
    v_mfma_f32_32x32x16_bf16 v[80:95], a[204:207], a[156:159], v[80:95]
    v_exp_f32 v45, v109
    v_exp_f32 v46, v110
    s_waitcnt lgkmcnt(3)
    v_mfma_f32_32x32x16_bf16 a[32:47], a[244:247], v[132:135], a[32:47]
    ds_read_b128 a[212:215], v29 offset:16384
    v_pk_add_f32 v[236:237], v[236:237], v[44:45]
    v_cvt_pk_bf16_f32 v150, v44, v45
    v_mfma_f32_32x32x16_bf16 a[48:63], a[244:247], v[140:143], a[48:63]
    s_cmp_eq_u32 s24, 0
    s_cbranch_scc0 F_qd_skip
    s_lshl_b32 s34, s28, 9
    s_lshl_b32 s35, s27, 7
    s_add_u32 s34, s34, s35
    s_add_u32 s34, s34, 0x2860000
    v_mov_b32 v62, s38
    v_mov_b32 v63, s39
    v_mov_b32 v60, 0
    s_mov_b64 exec, 1
    s_cmp_lg_u32 s68, 0
    s_cbranch_scc1 F_qd_fast
    buffer_store_dwordx2 v[62:63], v60, s[20:23], s34 offen sc1
    s_branch F_qd_done
F_qd_fast:
    buffer_store_dwordx2 v[62:63], v60, s[20:23], s34 offen
F_qd_done:
    s_mov_b64 exec, -1
F_qd_skip:
    s_waitcnt lgkmcnt(3)
    v_mfma_f32_32x32x16_bf16 v[64:79], a[208:211], a[160:163], v[64:79]
    ds_read_b128 a[216:219], v30 offset:16384
    v_exp_f32 v47, v111
    v_exp_f32 v40, v112
    v_mfma_f32_32x32x16_bf16 v[80:95], a[208:211], a[164:167], v[80:95]
    v_pk_add_f32 v[236:237], v[236:237], v[46:47]
    v_cvt_pk_bf16_f32 v151, v46, v47
    s_waitcnt lgkmcnt(2)
    v_mfma_f32_32x32x16_bf16 a[64:79], a[248:251], v[132:135], a[64:79]
    ds_read_b128 a[220:223], v31 offset:16384
    v_exp_f32 v41, v113
    v_exp_f32 v42, v114
    v_mfma_f32_32x32x16_bf16 a[80:95], a[248:251], v[140:143], a[80:95]
    v_pk_add_f32 v[238:239], v[40:41], 0 op_sel_hi:[1,0]
    v_cvt_pk_bf16_f32 v152, v40, v41
    s_waitcnt lgkmcnt(2)
    v_mfma_f32_32x32x16_bf16 v[64:79], a[212:215], a[168:171], v[64:79]
    ds_read_b64_tr_b16 a[252:253], v35 offset:61440
    ds_read_b64_tr_b16 a[254:255], v35 offset:63488
    v_exp_f32 v43, v115
    v_mfma_f32_32x32x16_bf16 v[80:95], a[212:215], a[172:175], v[80:95]
    v_exp_f32 v44, v116
    v_pk_add_f32 v[238:239], v[238:239], v[42:43]
    s_waitcnt lgkmcnt(3)
    v_mfma_f32_32x32x16_bf16 v[64:79], a[216:219], a[176:179], v[64:79]
    ds_read_b64_tr_b16 a[224:225], v36 offset:8192
    ds_read_b64_tr_b16 a[226:227], v36 offset:10240
    v_cvt_pk_bf16_f32 v153, v42, v43
    v_exp_f32 v45, v117
    v_mfma_f32_32x32x16_bf16 v[80:95], a[216:219], a[180:183], v[80:95]
    v_exp_f32 v46, v118
    v_pk_add_f32 v[238:239], v[238:239], v[44:45]
    s_waitcnt lgkmcnt(4)
    v_mfma_f32_32x32x16_bf16 v[64:79], a[220:223], a[184:187], v[64:79]
    ds_read_b64_tr_b16 a[228:229], v37 offset:8192
    ds_read_b64_tr_b16 a[230:231], v37 offset:10240
    v_cvt_pk_bf16_f32 v154, v44, v45
    v_exp_f32 v47, v119
    v_mfma_f32_32x32x16_bf16 v[80:95], a[220:223], a[188:191], v[80:95]
    v_exp_f32 v40, v120
    v_pk_add_f32 v[238:239], v[238:239], v[46:47]
    s_waitcnt lgkmcnt(4)
    v_mfma_f32_32x32x16_bf16 a[96:111], a[252:255], v[132:135], a[96:111]
    v_cvt_pk_bf16_f32 v155, v46, v47
    v_exp_f32 v41, v121
    v_exp_f32 v42, v122
    v_mfma_f32_32x32x16_bf16 a[112:127], a[252:255], v[140:143], a[112:127]
    v_pk_add_f32 v[238:239], v[238:239], v[40:41]
    v_cvt_pk_bf16_f32 v156, v40, v41
    v_exp_f32 v43, v123
    v_exp_f32 v44, v124
    v_pk_add_f32 v[238:239], v[238:239], v[42:43]
    v_cvt_pk_bf16_f32 v157, v42, v43
    v_exp_f32 v45, v125
    v_exp_f32 v46, v126
    v_pk_add_f32 v[238:239], v[238:239], v[44:45]
    v_cvt_pk_bf16_f32 v158, v44, v45
    v_exp_f32 v47, v127
    s_nop 0
    v_pk_add_f32 v[238:239], v[238:239], v[46:47]
    v_cvt_pk_bf16_f32 v159, v46, v47
    v_add_f32 v50, v236, v237
    v_add_f32 v51, v238, v239
    v_max_f32 v54, v50, v51
    v_cmp_lt_f32 vcc, s32, v54
    s_cbranch_vccnz F_stub1
F_back1:
    s_waitcnt vmcnt(8)
    s_barrier
    ds_read_b128 a[192:195], v24 offset:32768
    s_waitcnt lgkmcnt(3)
    v_mfma_f32_32x32x16_bf16 a[0:15], a[224:227], v[144:147], a[0:15]
    ds_read_b64_tr_b16 a[232:233], v38 offset:8192
    ds_read_b64_tr_b16 a[234:235], v38 offset:10240
    v_add_f32 v52, v52, v50
    v_add_f32 v53, v53, v51
    v_mfma_f32_32x32x16_bf16 a[16:31], a[224:227], v[152:155], a[16:31]
    v_exp_f32 v40, v64
    v_exp_f32 v41, v65
    s_waitcnt lgkmcnt(3)
    v_mfma_f32_32x32x16_bf16 a[32:47], a[228:231], v[144:147], a[32:47]
    ds_read_b128 a[196:199], v25 offset:32768
    v_exp_f32 v42, v66
    v_pk_add_f32 v[232:233], v[40:41], 0 op_sel_hi:[1,0]
    v_mfma_f32_32x32x16_bf16 a[48:63], a[228:231], v[152:155], a[48:63]
    s_add_u32 m0, s30, 147456
    s_add_u32 s31, s29, 49152
    buffer_load_dwordx4 v10, s[12:15], s31 offen nt lds
    v_cvt_pk_bf16_f32 v128, v40, v41
    s_waitcnt lgkmcnt(3)
    v_mfma_f32_32x32x16_bf16 v[96:111], a[192:195], a[128:131], v[160:175]
    ds_read_b64_tr_b16 a[236:237], v39 offset:8192
    ds_read_b64_tr_b16 a[238:239], v39 offset:10240
    v_exp_f32 v43, v67
    v_mfma_f32_32x32x16_bf16 v[112:127], a[192:195], a[132:135], v[176:191]
    v_exp_f32 v44, v68
    v_pk_add_f32 v[232:233], v[232:233], v[42:43]
    s_waitcnt lgkmcnt(3)
    v_mfma_f32_32x32x16_bf16 a[64:79], a[232:235], v[144:147], a[64:79]
    ds_read_b128 a[200:203], v26 offset:32768
    v_cvt_pk_bf16_f32 v129, v42, v43
    v_exp_f32 v45, v69
    v_mfma_f32_32x32x16_bf16 a[80:95], a[232:235], v[152:155], a[80:95]
    buffer_load_dwordx4 v11, s[12:15], s31 offen offset:1024 nt lds
    v_exp_f32 v46, v70
    s_waitcnt lgkmcnt(3)
    v_mfma_f32_32x32x16_bf16 v[96:111], a[196:199], a[136:139], v[96:111]
    ds_read_b64_tr_b16 a[240:241], v36 offset:12288
    ds_read_b64_tr_b16 a[242:243], v36 offset:14336
    v_pk_add_f32 v[232:233], v[232:233], v[44:45]
    v_cvt_pk_bf16_f32 v130, v44, v45
    v_mfma_f32_32x32x16_bf16 v[112:127], a[196:199], a[140:143], v[112:127]
    v_exp_f32 v47, v71
    v_exp_f32 v40, v72
    s_waitcnt lgkmcnt(3)
    v_mfma_f32_32x32x16_bf16 a[96:111], a[236:239], v[144:147], a[96:111]
    ds_read_b128 a[204:207], v27 offset:32768
    v_pk_add_f32 v[232:233], v[232:233], v[46:47]
    v_cvt_pk_bf16_f32 v131, v46, v47
    v_mfma_f32_32x32x16_bf16 a[112:127], a[236:239], v[152:155], a[112:127]
    s_add_u32 m0, s30, 155648
    s_nop 0
    buffer_load_dwordx4 v12, s[16:19], s31 offen nt lds
    s_waitcnt lgkmcnt(3)
    v_mfma_f32_32x32x16_bf16 v[96:111], a[200:203], a[144:147], v[96:111]
    ds_read_b64_tr_b16 a[244:245], v37 offset:12288
    ds_read_b64_tr_b16 a[246:247], v37 offset:14336
    v_exp_f32 v41, v73
    v_mfma_f32_32x32x16_bf16 v[112:127], a[200:203], a[148:151], v[112:127]
    v_exp_f32 v42, v74
    v_pk_add_f32 v[232:233], v[232:233], v[40:41]
    s_waitcnt lgkmcnt(3)
    v_mfma_f32_32x32x16_bf16 a[0:15], a[240:243], v[148:151], a[0:15]
    ds_read_b128 a[208:211], v28 offset:32768
    v_cvt_pk_bf16_f32 v132, v40, v41
    v_exp_f32 v43, v75
    v_mfma_f32_32x32x16_bf16 a[16:31], a[240:243], v[156:159], a[16:31]
    buffer_load_dwordx4 v12, s[16:19], s31 offen offset:1024 nt lds
    v_exp_f32 v44, v76
    s_waitcnt lgkmcnt(3)
    v_mfma_f32_32x32x16_bf16 v[96:111], a[204:207], a[152:155], v[96:111]
    ds_read_b64_tr_b16 a[248:249], v38 offset:12288
    ds_read_b64_tr_b16 a[250:251], v38 offset:14336
    v_pk_add_f32 v[232:233], v[232:233], v[42:43]
    v_cvt_pk_bf16_f32 v133, v42, v43
    v_mfma_f32_32x32x16_bf16 v[112:127], a[204:207], a[156:159], v[112:127]
    v_exp_f32 v45, v77
    v_exp_f32 v46, v78
    s_waitcnt lgkmcnt(3)
    v_mfma_f32_32x32x16_bf16 a[32:47], a[244:247], v[148:151], a[32:47]
    ds_read_b128 a[212:215], v29 offset:32768
    v_pk_add_f32 v[232:233], v[232:233], v[44:45]
    v_cvt_pk_bf16_f32 v134, v44, v45
    v_mfma_f32_32x32x16_bf16 a[48:63], a[244:247], v[156:159], a[48:63]
    v_exp_f32 v47, v79
    v_exp_f32 v40, v80
    s_waitcnt lgkmcnt(3)
    v_mfma_f32_32x32x16_bf16 v[96:111], a[208:211], a[160:163], v[96:111]
    ds_read_b128 a[216:219], v30 offset:32768
    v_pk_add_f32 v[232:233], v[232:233], v[46:47]
    v_cvt_pk_bf16_f32 v135, v46, v47
    v_mfma_f32_32x32x16_bf16 v[112:127], a[208:211], a[164:167], v[112:127]
    v_exp_f32 v41, v81
    v_exp_f32 v42, v82
    s_waitcnt lgkmcnt(2)
    v_mfma_f32_32x32x16_bf16 a[64:79], a[248:251], v[148:151], a[64:79]
    ds_read_b128 a[220:223], v31 offset:32768
    v_pk_add_f32 v[234:235], v[40:41], 0 op_sel_hi:[1,0]
    v_cvt_pk_bf16_f32 v136, v40, v41
    v_mfma_f32_32x32x16_bf16 a[80:95], a[248:251], v[156:159], a[80:95]
    v_exp_f32 v43, v83
    v_exp_f32 v44, v84
    s_waitcnt lgkmcnt(2)
    v_mfma_f32_32x32x16_bf16 v[96:111], a[212:215], a[168:171], v[96:111]
    ds_read_b64_tr_b16 a[252:253], v39 offset:12288
    ds_read_b64_tr_b16 a[254:255], v39 offset:14336
    v_pk_add_f32 v[234:235], v[234:235], v[42:43]
    v_cvt_pk_bf16_f32 v137, v42, v43
    v_mfma_f32_32x32x16_bf16 v[112:127], a[212:215], a[172:175], v[112:127]
    v_exp_f32 v45, v85
    v_exp_f32 v46, v86
    s_waitcnt lgkmcnt(3)
    v_mfma_f32_32x32x16_bf16 v[96:111], a[216:219], a[176:179], v[96:111]
    ds_read_b64_tr_b16 a[224:225], v36 offset:24576
    ds_read_b64_tr_b16 a[226:227], v36 offset:26624
    v_pk_add_f32 v[234:235], v[234:235], v[44:45]
    v_cvt_pk_bf16_f32 v138, v44, v45
    v_mfma_f32_32x32x16_bf16 v[112:127], a[216:219], a[180:183], v[112:127]
    v_exp_f32 v47, v87
    v_exp_f32 v40, v88
    s_waitcnt lgkmcnt(4)
    v_mfma_f32_32x32x16_bf16 v[96:111], a[220:223], a[184:187], v[96:111]
    ds_read_b64_tr_b16 a[228:229], v37 offset:24576
    ds_read_b64_tr_b16 a[230:231], v37 offset:26624
    v_pk_add_f32 v[234:235], v[234:235], v[46:47]
    v_cvt_pk_bf16_f32 v139, v46, v47
    v_mfma_f32_32x32x16_bf16 v[112:127], a[220:223], a[188:191], v[112:127]
    v_exp_f32 v41, v89
    v_exp_f32 v42, v90
    s_waitcnt lgkmcnt(4)
    v_mfma_f32_32x32x16_bf16 a[96:111], a[252:255], v[148:151], a[96:111]
    v_pk_add_f32 v[234:235], v[234:235], v[40:41]
    v_cvt_pk_bf16_f32 v140, v40, v41
    v_exp_f32 v43, v91
    v_mfma_f32_32x32x16_bf16 a[112:127], a[252:255], v[156:159], a[112:127]
    v_exp_f32 v44, v92
    v_pk_add_f32 v[234:235], v[234:235], v[42:43]
    v_cvt_pk_bf16_f32 v141, v42, v43
    v_exp_f32 v45, v93
    v_exp_f32 v46, v94
    v_pk_add_f32 v[234:235], v[234:235], v[44:45]
    v_cvt_pk_bf16_f32 v142, v44, v45
    v_exp_f32 v47, v95
    s_nop 0
    v_pk_add_f32 v[234:235], v[234:235], v[46:47]
    v_cvt_pk_bf16_f32 v143, v46, v47
    v_add_f32 v48, v232, v233
    v_add_f32 v49, v234, v235
    v_max_f32 v54, v48, v49
    v_cmp_lt_f32 vcc, s32, v54
    s_cbranch_vccnz F_stub2
F_back2:
    s_waitcnt vmcnt(8)
    s_barrier
    ds_read_b128 a[192:195], v24 offset:49152
    s_waitcnt lgkmcnt(3)
    v_mfma_f32_32x32x16_bf16 a[0:15], a[224:227], v[128:131], a[0:15]
    ds_read_b64_tr_b16 a[232:233], v38 offset:24576
    ds_read_b64_tr_b16 a[234:235], v38 offset:26624
    v_add_f32 v52, v52, v48
    v_add_f32 v53, v53, v49
    v_mfma_f32_32x32x16_bf16 a[16:31], a[224:227], v[136:139], a[16:31]
    v_exp_f32 v40, v96
    v_exp_f32 v41, v97
    s_waitcnt lgkmcnt(3)
    v_mfma_f32_32x32x16_bf16 a[32:47], a[228:231], v[128:131], a[32:47]
    ds_read_b128 a[196:199], v25 offset:49152
    v_exp_f32 v42, v98
    v_pk_add_f32 v[236:237], v[40:41], 0 op_sel_hi:[1,0]
    v_mfma_f32_32x32x16_bf16 a[48:63], a[228:231], v[136:139], a[48:63]
    s_add_u32 m0, s30, 0
    s_add_u32 s31, s29, 57344
    buffer_load_dwordx4 v10, s[12:15], s31 offen nt lds
    v_cvt_pk_bf16_f32 v144, v40, v41
    s_waitcnt lgkmcnt(3)
    v_mfma_f32_32x32x16_bf16 v[64:79], a[192:195], a[128:131], v[160:175]
    ds_read_b64_tr_b16 a[236:237], v39 offset:24576
    ds_read_b64_tr_b16 a[238:239], v39 offset:26624
    v_exp_f32 v43, v99
    v_mfma_f32_32x32x16_bf16 v[80:95], a[192:195], a[132:135], v[176:191]
    v_exp_f32 v44, v100
    v_pk_add_f32 v[236:237], v[236:237], v[42:43]
    s_waitcnt lgkmcnt(3)
    v_mfma_f32_32x32x16_bf16 a[64:79], a[232:235], v[128:131], a[64:79]
    ds_read_b128 a[200:203], v26 offset:49152
    v_cvt_pk_bf16_f32 v145, v42, v43
    v_exp_f32 v45, v101
    v_mfma_f32_32x32x16_bf16 a[80:95], a[232:235], v[136:139], a[80:95]
    buffer_load_dwordx4 v11, s[12:15], s31 offen offset:1024 nt lds
    v_exp_f32 v46, v102
    s_waitcnt lgkmcnt(3)
    v_mfma_f32_32x32x16_bf16 v[64:79], a[196:199], a[136:139], v[64:79]
    ds_read_b64_tr_b16 a[240:241], v36 offset:28672
    ds_read_b64_tr_b16 a[242:243], v36 offset:30720
    v_pk_add_f32 v[236:237], v[236:237], v[44:45]
    v_cvt_pk_bf16_f32 v146, v44, v45
    v_mfma_f32_32x32x16_bf16 v[80:95], a[196:199], a[140:143], v[80:95]
    v_exp_f32 v47, v103
    v_exp_f32 v40, v104
    s_waitcnt lgkmcnt(3)
    v_mfma_f32_32x32x16_bf16 a[96:111], a[236:239], v[128:131], a[96:111]
    ds_read_b128 a[204:207], v27 offset:49152
    v_pk_add_f32 v[236:237], v[236:237], v[46:47]
    v_cvt_pk_bf16_f32 v147, v46, v47
    v_mfma_f32_32x32x16_bf16 a[112:127], a[236:239], v[136:139], a[112:127]
    s_add_u32 m0, s30, 8192
    s_nop 0
    buffer_load_dwordx4 v12, s[16:19], s31 offen nt lds
    s_waitcnt lgkmcnt(3)
    v_mfma_f32_32x32x16_bf16 v[64:79], a[200:203], a[144:147], v[64:79]
    ds_read_b64_tr_b16 a[244:245], v37 offset:28672
    ds_read_b64_tr_b16 a[246:247], v37 offset:30720
    v_exp_f32 v41, v105
    v_mfma_f32_32x32x16_bf16 v[80:95], a[200:203], a[148:151], v[80:95]
    v_exp_f32 v42, v106
    v_pk_add_f32 v[236:237], v[236:237], v[40:41]
    s_waitcnt lgkmcnt(3)
    v_mfma_f32_32x32x16_bf16 a[0:15], a[240:243], v[132:135], a[0:15]
    ds_read_b128 a[208:211], v28 offset:49152
    v_cvt_pk_bf16_f32 v148, v40, v41
    v_exp_f32 v43, v107
    v_mfma_f32_32x32x16_bf16 a[16:31], a[240:243], v[140:143], a[16:31]
    buffer_load_dwordx4 v12, s[16:19], s31 offen offset:1024 nt lds
    v_exp_f32 v44, v108
    s_waitcnt lgkmcnt(3)
    v_mfma_f32_32x32x16_bf16 v[64:79], a[204:207], a[152:155], v[64:79]
    ds_read_b64_tr_b16 a[248:249], v38 offset:28672
    ds_read_b64_tr_b16 a[250:251], v38 offset:30720
    v_pk_add_f32 v[236:237], v[236:237], v[42:43]
    v_cvt_pk_bf16_f32 v149, v42, v43
    v_mfma_f32_32x32x16_bf16 v[80:95], a[204:207], a[156:159], v[80:95]
    v_exp_f32 v45, v109
    v_exp_f32 v46, v110
    s_waitcnt lgkmcnt(3)
    v_mfma_f32_32x32x16_bf16 a[32:47], a[244:247], v[132:135], a[32:47]
    ds_read_b128 a[212:215], v29 offset:49152
    v_pk_add_f32 v[236:237], v[236:237], v[44:45]
    v_cvt_pk_bf16_f32 v150, v44, v45
    v_mfma_f32_32x32x16_bf16 a[48:63], a[244:247], v[140:143], a[48:63]
    v_exp_f32 v47, v111
    v_exp_f32 v40, v112
    s_waitcnt lgkmcnt(3)
    v_mfma_f32_32x32x16_bf16 v[64:79], a[208:211], a[160:163], v[64:79]
    ds_read_b128 a[216:219], v30 offset:49152
    v_pk_add_f32 v[236:237], v[236:237], v[46:47]
    v_cvt_pk_bf16_f32 v151, v46, v47
    v_mfma_f32_32x32x16_bf16 v[80:95], a[208:211], a[164:167], v[80:95]
    v_exp_f32 v41, v113
    v_exp_f32 v42, v114
    s_waitcnt lgkmcnt(2)
    v_mfma_f32_32x32x16_bf16 a[64:79], a[248:251], v[132:135], a[64:79]
    ds_read_b128 a[220:223], v31 offset:49152
    v_pk_add_f32 v[238:239], v[40:41], 0 op_sel_hi:[1,0]
    v_cvt_pk_bf16_f32 v152, v40, v41
    v_mfma_f32_32x32x16_bf16 a[80:95], a[248:251], v[140:143], a[80:95]
    v_exp_f32 v43, v115
    v_exp_f32 v44, v116
    s_waitcnt lgkmcnt(2)
    v_mfma_f32_32x32x16_bf16 v[64:79], a[212:215], a[168:171], v[64:79]
    ds_read_b64_tr_b16 a[252:253], v39 offset:28672
    ds_read_b64_tr_b16 a[254:255], v39 offset:30720
    v_pk_add_f32 v[238:239], v[238:239], v[42:43]
    v_cvt_pk_bf16_f32 v153, v42, v43
    v_mfma_f32_32x32x16_bf16 v[80:95], a[212:215], a[172:175], v[80:95]
    v_exp_f32 v45, v117
    v_exp_f32 v46, v118
    s_waitcnt lgkmcnt(3)
    v_mfma_f32_32x32x16_bf16 v[64:79], a[216:219], a[176:179], v[64:79]
    ds_read_b64_tr_b16 a[224:225], v36 offset:40960
    ds_read_b64_tr_b16 a[226:227], v36 offset:43008
    v_pk_add_f32 v[238:239], v[238:239], v[44:45]
    v_cvt_pk_bf16_f32 v154, v44, v45
    v_mfma_f32_32x32x16_bf16 v[80:95], a[216:219], a[180:183], v[80:95]
    v_exp_f32 v47, v119
    v_exp_f32 v40, v120
    s_waitcnt lgkmcnt(4)
    v_mfma_f32_32x32x16_bf16 v[64:79], a[220:223], a[184:187], v[64:79]
    ds_read_b64_tr_b16 a[228:229], v37 offset:40960
    ds_read_b64_tr_b16 a[230:231], v37 offset:43008
    v_pk_add_f32 v[238:239], v[238:239], v[46:47]
    v_cvt_pk_bf16_f32 v155, v46, v47
    v_mfma_f32_32x32x16_bf16 v[80:95], a[220:223], a[188:191], v[80:95]
    v_exp_f32 v41, v121
    v_exp_f32 v42, v122
    s_waitcnt lgkmcnt(4)
    v_mfma_f32_32x32x16_bf16 a[96:111], a[252:255], v[132:135], a[96:111]
    v_pk_add_f32 v[238:239], v[238:239], v[40:41]
    v_cvt_pk_bf16_f32 v156, v40, v41
    v_exp_f32 v43, v123
    v_mfma_f32_32x32x16_bf16 a[112:127], a[252:255], v[140:143], a[112:127]
    v_exp_f32 v44, v124
    v_pk_add_f32 v[238:239], v[238:239], v[42:43]
    v_cvt_pk_bf16_f32 v157, v42, v43
    v_exp_f32 v45, v125
    v_exp_f32 v46, v126
    v_pk_add_f32 v[238:239], v[238:239], v[44:45]
    v_cvt_pk_bf16_f32 v158, v44, v45
    v_exp_f32 v47, v127
    s_nop 0
    v_pk_add_f32 v[238:239], v[238:239], v[46:47]
    v_cvt_pk_bf16_f32 v159, v46, v47
    v_add_f32 v50, v236, v237
    v_add_f32 v51, v238, v239
    v_max_f32 v54, v50, v51
    v_cmp_lt_f32 vcc, s32, v54
    s_cbranch_vccnz F_stub3
F_back3:
    s_waitcnt vmcnt(8)
    s_barrier
    ds_read_b128 a[192:195], v192 offset:0
    s_waitcnt lgkmcnt(3)
    v_mfma_f32_32x32x16_bf16 a[0:15], a[224:227], v[144:147], a[0:15]
    ds_read_b64_tr_b16 a[232:233], v38 offset:40960
    ds_read_b64_tr_b16 a[234:235], v38 offset:43008
    v_add_f32 v52, v52, v50
    v_add_f32 v53, v53, v51
    v_mfma_f32_32x32x16_bf16 a[16:31], a[224:227], v[152:155], a[16:31]
    v_exp_f32 v40, v64
    v_exp_f32 v41, v65
    s_waitcnt lgkmcnt(3)
    v_mfma_f32_32x32x16_bf16 a[32:47], a[228:231], v[144:147], a[32:47]
    ds_read_b128 a[196:199], v193 offset:0
    v_exp_f32 v42, v66
    v_pk_add_f32 v[232:233], v[40:41], 0 op_sel_hi:[1,0]
    v_mfma_f32_32x32x16_bf16 a[48:63], a[228:231], v[152:155], a[48:63]
    s_add_u32 m0, s30, 16384
    s_add_u32 s31, s29, 65536
    buffer_load_dwordx4 v10, s[12:15], s31 offen nt lds
    v_cvt_pk_bf16_f32 v128, v40, v41
    s_waitcnt lgkmcnt(3)
    v_mfma_f32_32x32x16_bf16 v[96:111], a[192:195], a[128:131], v[160:175]
    ds_read_b64_tr_b16 a[236:237], v39 offset:40960
    ds_read_b64_tr_b16 a[238:239], v39 offset:43008
    v_exp_f32 v43, v67
    v_mfma_f32_32x32x16_bf16 v[112:127], a[192:195], a[132:135], v[176:191]
    v_exp_f32 v44, v68
    v_pk_add_f32 v[232:233], v[232:233], v[42:43]
    s_waitcnt lgkmcnt(3)
    v_mfma_f32_32x32x16_bf16 a[64:79], a[232:235], v[144:147], a[64:79]
    ds_read_b128 a[200:203], v194 offset:0
    v_cvt_pk_bf16_f32 v129, v42, v43
    v_exp_f32 v45, v69
    v_mfma_f32_32x32x16_bf16 a[80:95], a[232:235], v[152:155], a[80:95]
    buffer_load_dwordx4 v11, s[12:15], s31 offen offset:1024 nt lds
    v_exp_f32 v46, v70
    s_waitcnt lgkmcnt(3)
    v_mfma_f32_32x32x16_bf16 v[96:111], a[196:199], a[136:139], v[96:111]
    ds_read_b64_tr_b16 a[240:241], v36 offset:45056
    ds_read_b64_tr_b16 a[242:243], v36 offset:47104
    v_pk_add_f32 v[232:233], v[232:233], v[44:45]
    v_cvt_pk_bf16_f32 v130, v44, v45
    v_mfma_f32_32x32x16_bf16 v[112:127], a[196:199], a[140:143], v[112:127]
    v_exp_f32 v47, v71
    v_exp_f32 v40, v72
    s_waitcnt lgkmcnt(3)
    v_mfma_f32_32x32x16_bf16 a[96:111], a[236:239], v[144:147], a[96:111]
    ds_read_b128 a[204:207], v195 offset:0
    v_pk_add_f32 v[232:233], v[232:233], v[46:47]
    v_cvt_pk_bf16_f32 v131, v46, v47
    v_mfma_f32_32x32x16_bf16 a[112:127], a[236:239], v[152:155], a[112:127]
    s_add_u32 m0, s30, 24576
    s_nop 0
    buffer_load_dwordx4 v12, s[16:19], s31 offen nt lds
    s_waitcnt lgkmcnt(3)
    v_mfma_f32_32x32x16_bf16 v[96:111], a[200:203], a[144:147], v[96:111]
    ds_read_b64_tr_b16 a[244:245], v37 offset:45056
    ds_read_b64_tr_b16 a[246:247], v37 offset:47104
    v_exp_f32 v41, v73
    v_mfma_f32_32x32x16_bf16 v[112:127], a[200:203], a[148:151], v[112:127]
    v_exp_f32 v42, v74
    v_pk_add_f32 v[232:233], v[232:233], v[40:41]
    s_waitcnt lgkmcnt(3)
    v_mfma_f32_32x32x16_bf16 a[0:15], a[240:243], v[148:151], a[0:15]
    ds_read_b128 a[208:211], v196 offset:0
    v_cvt_pk_bf16_f32 v132, v40, v41
    v_exp_f32 v43, v75
    v_mfma_f32_32x32x16_bf16 a[16:31], a[240:243], v[156:159], a[16:31]
    buffer_load_dwordx4 v12, s[16:19], s31 offen offset:1024 nt lds
    v_exp_f32 v44, v76
    s_waitcnt lgkmcnt(3)
    v_mfma_f32_32x32x16_bf16 v[96:111], a[204:207], a[152:155], v[96:111]
    ds_read_b64_tr_b16 a[248:249], v38 offset:45056
    ds_read_b64_tr_b16 a[250:251], v38 offset:47104
    v_pk_add_f32 v[232:233], v[232:233], v[42:43]
    v_cvt_pk_bf16_f32 v133, v42, v43
    v_mfma_f32_32x32x16_bf16 v[112:127], a[204:207], a[156:159], v[112:127]
    v_exp_f32 v45, v77
    v_exp_f32 v46, v78
    s_waitcnt lgkmcnt(3)
    v_mfma_f32_32x32x16_bf16 a[32:47], a[244:247], v[148:151], a[32:47]
    ds_read_b128 a[212:215], v197 offset:0
    v_pk_add_f32 v[232:233], v[232:233], v[44:45]
    v_cvt_pk_bf16_f32 v134, v44, v45
    v_mfma_f32_32x32x16_bf16 a[48:63], a[244:247], v[156:159], a[48:63]
    v_exp_f32 v47, v79
    v_exp_f32 v40, v80
    s_waitcnt lgkmcnt(3)
    v_mfma_f32_32x32x16_bf16 v[96:111], a[208:211], a[160:163], v[96:111]
    ds_read_b128 a[216:219], v198 offset:0
    v_pk_add_f32 v[232:233], v[232:233], v[46:47]
    v_cvt_pk_bf16_f32 v135, v46, v47
    v_mfma_f32_32x32x16_bf16 v[112:127], a[208:211], a[164:167], v[112:127]
    v_exp_f32 v41, v81
    v_exp_f32 v42, v82
    s_waitcnt lgkmcnt(2)
    v_mfma_f32_32x32x16_bf16 a[64:79], a[248:251], v[148:151], a[64:79]
    ds_read_b128 a[220:223], v199 offset:0
    v_pk_add_f32 v[234:235], v[40:41], 0 op_sel_hi:[1,0]
    v_cvt_pk_bf16_f32 v136, v40, v41
    v_mfma_f32_32x32x16_bf16 a[80:95], a[248:251], v[156:159], a[80:95]
    v_exp_f32 v43, v83
    v_exp_f32 v44, v84
    s_waitcnt lgkmcnt(2)
    v_mfma_f32_32x32x16_bf16 v[96:111], a[212:215], a[168:171], v[96:111]
    ds_read_b64_tr_b16 a[252:253], v39 offset:45056
    ds_read_b64_tr_b16 a[254:255], v39 offset:47104
    v_pk_add_f32 v[234:235], v[234:235], v[42:43]
    v_cvt_pk_bf16_f32 v137, v42, v43
    v_mfma_f32_32x32x16_bf16 v[112:127], a[212:215], a[172:175], v[112:127]
    v_exp_f32 v45, v85
    v_exp_f32 v46, v86
    s_waitcnt lgkmcnt(3)
    v_mfma_f32_32x32x16_bf16 v[96:111], a[216:219], a[176:179], v[96:111]
    ds_read_b64_tr_b16 a[224:225], v36 offset:57344
    ds_read_b64_tr_b16 a[226:227], v36 offset:59392
    v_pk_add_f32 v[234:235], v[234:235], v[44:45]
    v_cvt_pk_bf16_f32 v138, v44, v45
    v_mfma_f32_32x32x16_bf16 v[112:127], a[216:219], a[180:183], v[112:127]
    v_exp_f32 v47, v87
    v_exp_f32 v40, v88
    s_waitcnt lgkmcnt(4)
    v_mfma_f32_32x32x16_bf16 v[96:111], a[220:223], a[184:187], v[96:111]
    ds_read_b64_tr_b16 a[228:229], v37 offset:57344
    ds_read_b64_tr_b16 a[230:231], v37 offset:59392
    v_pk_add_f32 v[234:235], v[234:235], v[46:47]
    v_cvt_pk_bf16_f32 v139, v46, v47
    v_mfma_f32_32x32x16_bf16 v[112:127], a[220:223], a[188:191], v[112:127]
    v_exp_f32 v41, v89
    v_exp_f32 v42, v90
    s_waitcnt lgkmcnt(4)
    v_mfma_f32_32x32x16_bf16 a[96:111], a[252:255], v[148:151], a[96:111]
    v_pk_add_f32 v[234:235], v[234:235], v[40:41]
    v_cvt_pk_bf16_f32 v140, v40, v41
    v_exp_f32 v43, v91
    v_mfma_f32_32x32x16_bf16 a[112:127], a[252:255], v[156:159], a[112:127]
    v_exp_f32 v44, v92
    v_pk_add_f32 v[234:235], v[234:235], v[42:43]
    v_cvt_pk_bf16_f32 v141, v42, v43
    v_exp_f32 v45, v93
    v_exp_f32 v46, v94
    v_pk_add_f32 v[234:235], v[234:235], v[44:45]
    v_cvt_pk_bf16_f32 v142, v44, v45
    v_exp_f32 v47, v95
    s_nop 0
    v_pk_add_f32 v[234:235], v[234:235], v[46:47]
    v_cvt_pk_bf16_f32 v143, v46, v47
    v_add_f32 v48, v232, v233
    v_add_f32 v49, v234, v235
    v_max_f32 v54, v48, v49
    v_cmp_lt_f32 vcc, s32, v54
    s_cbranch_vccnz F_stub4
F_back4:
    s_waitcnt vmcnt(8)
    s_barrier
    ds_read_b128 a[192:195], v192 offset:16384
    s_waitcnt lgkmcnt(3)
    v_mfma_f32_32x32x16_bf16 a[0:15], a[224:227], v[128:131], a[0:15]
    ds_read_b64_tr_b16 a[232:233], v38 offset:57344
    ds_read_b64_tr_b16 a[234:235], v38 offset:59392
    v_add_f32 v52, v52, v48
    v_add_f32 v53, v53, v49
    v_mfma_f32_32x32x16_bf16 a[16:31], a[224:227], v[136:139], a[16:31]
    v_exp_f32 v40, v96
    v_exp_f32 v41, v97
    s_waitcnt lgkmcnt(3)
    v_mfma_f32_32x32x16_bf16 a[32:47], a[228:231], v[128:131], a[32:47]
    ds_read_b128 a[196:199], v193 offset:16384
    v_exp_f32 v42, v98
    v_pk_add_f32 v[236:237], v[40:41], 0 op_sel_hi:[1,0]
    v_mfma_f32_32x32x16_bf16 a[48:63], a[228:231], v[136:139], a[48:63]
    s_add_u32 m0, s30, 32768
    s_add_u32 s31, s29, 73728
    buffer_load_dwordx4 v10, s[12:15], s31 offen nt lds
    v_cvt_pk_bf16_f32 v144, v40, v41
    s_waitcnt lgkmcnt(3)
    v_mfma_f32_32x32x16_bf16 v[64:79], a[192:195], a[128:131], v[160:175]
    ds_read_b64_tr_b16 a[236:237], v39 offset:57344
    ds_read_b64_tr_b16 a[238:239], v39 offset:59392
    v_exp_f32 v43, v99
    v_mfma_f32_32x32x16_bf16 v[80:95], a[192:195], a[132:135], v[176:191]
    v_exp_f32 v44, v100
    v_pk_add_f32 v[236:237], v[236:237], v[42:43]
    s_waitcnt lgkmcnt(3)
    v_mfma_f32_32x32x16_bf16 a[64:79], a[232:235], v[128:131], a[64:79]
    ds_read_b128 a[200:203], v194 offset:16384
    v_cvt_pk_bf16_f32 v145, v42, v43
    v_exp_f32 v45, v101
    v_mfma_f32_32x32x16_bf16 a[80:95], a[232:235], v[136:139], a[80:95]
    buffer_load_dwordx4 v11, s[12:15], s31 offen offset:1024 nt lds
    v_exp_f32 v46, v102
    s_waitcnt lgkmcnt(3)
    v_mfma_f32_32x32x16_bf16 v[64:79], a[196:199], a[136:139], v[64:79]
    ds_read_b64_tr_b16 a[240:241], v36 offset:61440
    ds_read_b64_tr_b16 a[242:243], v36 offset:63488
    v_pk_add_f32 v[236:237], v[236:237], v[44:45]
    v_cvt_pk_bf16_f32 v146, v44, v45
    v_mfma_f32_32x32x16_bf16 v[80:95], a[196:199], a[140:143], v[80:95]
    v_exp_f32 v47, v103
    v_exp_f32 v40, v104
    s_waitcnt lgkmcnt(3)
    v_mfma_f32_32x32x16_bf16 a[96:111], a[236:239], v[128:131], a[96:111]
    ds_read_b128 a[204:207], v195 offset:16384
    v_pk_add_f32 v[236:237], v[236:237], v[46:47]
    v_cvt_pk_bf16_f32 v147, v46, v47
    v_mfma_f32_32x32x16_bf16 a[112:127], a[236:239], v[136:139], a[112:127]
    s_add_u32 m0, s30, 40960
    s_nop 0
    buffer_load_dwordx4 v12, s[16:19], s31 offen nt lds
    s_waitcnt lgkmcnt(3)
    v_mfma_f32_32x32x16_bf16 v[64:79], a[200:203], a[144:147], v[64:79]
    ds_read_b64_tr_b16 a[244:245], v37 offset:61440
    ds_read_b64_tr_b16 a[246:247], v37 offset:63488
    v_exp_f32 v41, v105
    v_mfma_f32_32x32x16_bf16 v[80:95], a[200:203], a[148:151], v[80:95]
    v_exp_f32 v42, v106
    v_pk_add_f32 v[236:237], v[236:237], v[40:41]
    s_waitcnt lgkmcnt(3)
    v_mfma_f32_32x32x16_bf16 a[0:15], a[240:243], v[132:135], a[0:15]
    ds_read_b128 a[208:211], v196 offset:16384
    v_cvt_pk_bf16_f32 v148, v40, v41
    v_exp_f32 v43, v107
    v_mfma_f32_32x32x16_bf16 a[16:31], a[240:243], v[140:143], a[16:31]
    buffer_load_dwordx4 v12, s[16:19], s31 offen offset:1024 nt lds
    v_exp_f32 v44, v108
    s_waitcnt lgkmcnt(3)
    v_mfma_f32_32x32x16_bf16 v[64:79], a[204:207], a[152:155], v[64:79]
    ds_read_b64_tr_b16 a[248:249], v38 offset:61440
    ds_read_b64_tr_b16 a[250:251], v38 offset:63488
    v_pk_add_f32 v[236:237], v[236:237], v[42:43]
    v_cvt_pk_bf16_f32 v149, v42, v43
    v_mfma_f32_32x32x16_bf16 v[80:95], a[204:207], a[156:159], v[80:95]
    v_exp_f32 v45, v109
    v_exp_f32 v46, v110
    s_waitcnt lgkmcnt(3)
    v_mfma_f32_32x32x16_bf16 a[32:47], a[244:247], v[132:135], a[32:47]
    ds_read_b128 a[212:215], v197 offset:16384
    v_pk_add_f32 v[236:237], v[236:237], v[44:45]
    v_cvt_pk_bf16_f32 v150, v44, v45
    v_mfma_f32_32x32x16_bf16 a[48:63], a[244:247], v[140:143], a[48:63]
    v_exp_f32 v47, v111
    v_exp_f32 v40, v112
    s_waitcnt lgkmcnt(3)
    v_mfma_f32_32x32x16_bf16 v[64:79], a[208:211], a[160:163], v[64:79]
    ds_read_b128 a[216:219], v198 offset:16384
    v_pk_add_f32 v[236:237], v[236:237], v[46:47]
    v_cvt_pk_bf16_f32 v151, v46, v47
    v_mfma_f32_32x32x16_bf16 v[80:95], a[208:211], a[164:167], v[80:95]
    v_exp_f32 v41, v113
    v_exp_f32 v42, v114
    s_waitcnt lgkmcnt(2)
    v_mfma_f32_32x32x16_bf16 a[64:79], a[248:251], v[132:135], a[64:79]
    ds_read_b128 a[220:223], v199 offset:16384
    v_pk_add_f32 v[238:239], v[40:41], 0 op_sel_hi:[1,0]
    v_cvt_pk_bf16_f32 v152, v40, v41
    v_mfma_f32_32x32x16_bf16 a[80:95], a[248:251], v[140:143], a[80:95]
    v_exp_f32 v43, v115
    v_exp_f32 v44, v116
    s_waitcnt lgkmcnt(2)
    v_mfma_f32_32x32x16_bf16 v[64:79], a[212:215], a[168:171], v[64:79]
    ds_read_b64_tr_b16 a[252:253], v39 offset:61440
    ds_read_b64_tr_b16 a[254:255], v39 offset:63488
    v_pk_add_f32 v[238:239], v[238:239], v[42:43]
    v_cvt_pk_bf16_f32 v153, v42, v43
    v_mfma_f32_32x32x16_bf16 v[80:95], a[212:215], a[172:175], v[80:95]
    v_exp_f32 v45, v117
    v_exp_f32 v46, v118
    s_waitcnt lgkmcnt(3)
    v_mfma_f32_32x32x16_bf16 v[64:79], a[216:219], a[176:179], v[64:79]
    ds_read_b64_tr_b16 a[224:225], v200 offset:8192
    ds_read_b64_tr_b16 a[226:227], v200 offset:10240
    v_pk_add_f32 v[238:239], v[238:239], v[44:45]
    v_cvt_pk_bf16_f32 v154, v44, v45
    v_mfma_f32_32x32x16_bf16 v[80:95], a[216:219], a[180:183], v[80:95]
    v_exp_f32 v47, v119
    v_exp_f32 v40, v120
    s_waitcnt lgkmcnt(4)
    v_mfma_f32_32x32x16_bf16 v[64:79], a[220:223], a[184:187], v[64:79]
    ds_read_b64_tr_b16 a[228:229], v201 offset:8192
    ds_read_b64_tr_b16 a[230:231], v201 offset:10240
    v_pk_add_f32 v[238:239], v[238:239], v[46:47]
    v_cvt_pk_bf16_f32 v155, v46, v47
    v_mfma_f32_32x32x16_bf16 v[80:95], a[220:223], a[188:191], v[80:95]
    v_exp_f32 v41, v121
    v_exp_f32 v42, v122
    s_waitcnt lgkmcnt(4)
    v_mfma_f32_32x32x16_bf16 a[96:111], a[252:255], v[132:135], a[96:111]
    v_pk_add_f32 v[238:239], v[238:239], v[40:41]
    v_cvt_pk_bf16_f32 v156, v40, v41
    v_exp_f32 v43, v123
    v_mfma_f32_32x32x16_bf16 a[112:127], a[252:255], v[140:143], a[112:127]
    v_exp_f32 v44, v124
    v_pk_add_f32 v[238:239], v[238:239], v[42:43]
    v_cvt_pk_bf16_f32 v157, v42, v43
    v_exp_f32 v45, v125
    v_exp_f32 v46, v126
    v_pk_add_f32 v[238:239], v[238:239], v[44:45]
    v_cvt_pk_bf16_f32 v158, v44, v45
    v_exp_f32 v47, v127
    s_nop 0
    v_pk_add_f32 v[238:239], v[238:239], v[46:47]
    v_cvt_pk_bf16_f32 v159, v46, v47
    v_add_f32 v50, v236, v237
    v_add_f32 v51, v238, v239
    v_max_f32 v54, v50, v51
    v_cmp_lt_f32 vcc, s32, v54
    s_cbranch_vccnz F_stub5
F_back5:
    s_waitcnt vmcnt(8)
    s_barrier
    ds_read_b128 a[192:195], v16 offset:0
    s_waitcnt lgkmcnt(3)
    v_mfma_f32_32x32x16_bf16 a[0:15], a[224:227], v[144:147], a[0:15]
    ds_read_b64_tr_b16 a[232:233], v202 offset:8192
    ds_read_b64_tr_b16 a[234:235], v202 offset:10240
    v_add_f32 v52, v52, v50
    v_add_f32 v53, v53, v51
    v_mfma_f32_32x32x16_bf16 a[16:31], a[224:227], v[152:155], a[16:31]
    v_exp_f32 v40, v64
    v_exp_f32 v41, v65
    s_waitcnt lgkmcnt(3)
    v_mfma_f32_32x32x16_bf16 a[32:47], a[228:231], v[144:147], a[32:47]
    ds_read_b128 a[196:199], v17 offset:0
    v_exp_f32 v42, v66
    v_add_f32 v48, v40, v41
    v_cvt_pk_bf16_f32 v128, v40, v41
    v_mfma_f32_32x32x16_bf16 a[48:63], a[228:231], v[152:155], a[48:63]
    s_add_u32 m0, s30, 49152
    s_add_u32 s31, s29, 81920
    buffer_load_dwordx4 v10, s[12:15], s31 offen nt lds
    s_waitcnt lgkmcnt(3)
    v_mfma_f32_32x32x16_bf16 v[96:111], a[192:195], a[128:131], v[160:175]
    ds_read_b64_tr_b16 a[236:237], v203 offset:8192
    ds_read_b64_tr_b16 a[238:239], v203 offset:10240
    v_exp_f32 v43, v67
    v_add_f32 v48, v48, v42
    v_mfma_f32_32x32x16_bf16 v[112:127], a[192:195], a[132:135], v[176:191]
    v_exp_f32 v44, v68
    v_add_f32 v48, v48, v43
    v_cvt_pk_bf16_f32 v129, v42, v43
    s_waitcnt lgkmcnt(3)
    v_mfma_f32_32x32x16_bf16 a[64:79], a[232:235], v[144:147], a[64:79]
    ds_read_b128 a[200:203], v18 offset:0
    v_exp_f32 v45, v69
    v_add_f32 v48, v48, v44
    v_mfma_f32_32x32x16_bf16 a[80:95], a[232:235], v[152:155], a[80:95]
    buffer_load_dwordx4 v11, s[12:15], s31 offen offset:1024 nt lds
    v_exp_f32 v46, v70
    v_add_f32 v48, v48, v45
    s_waitcnt lgkmcnt(3)
    v_mfma_f32_32x32x16_bf16 v[96:111], a[196:199], a[136:139], v[96:111]
    ds_read_b64_tr_b16 a[240:241], v200 offset:12288
    ds_read_b64_tr_b16 a[242:243], v200 offset:14336
    v_cvt_pk_bf16_f32 v130, v44, v45
    v_exp_f32 v47, v71
    v_mfma_f32_32x32x16_bf16 v[112:127], a[196:199], a[140:143], v[112:127]
    v_add_f32 v48, v48, v46
    v_exp_f32 v40, v72
    v_add_f32 v48, v48, v47
    s_waitcnt lgkmcnt(3)
    v_mfma_f32_32x32x16_bf16 a[96:111], a[236:239], v[144:147], a[96:111]
    ds_read_b128 a[204:207], v19 offset:0
    v_cvt_pk_bf16_f32 v131, v46, v47
    v_exp_f32 v41, v73
    v_add_f32 v48, v48, v40
    v_mfma_f32_32x32x16_bf16 a[112:127], a[236:239], v[152:155], a[112:127]
    s_add_u32 m0, s30, 57344
    s_nop 0
    buffer_load_dwordx4 v12, s[16:19], s31 offen nt lds
    s_waitcnt lgkmcnt(3)
    v_mfma_f32_32x32x16_bf16 v[96:111], a[200:203], a[144:147], v[96:111]
    ds_read_b64_tr_b16 a[244:245], v201 offset:12288
    ds_read_b64_tr_b16 a[246:247], v201 offset:14336
    v_exp_f32 v42, v74
    v_add_f32 v48, v48, v41
    v_mfma_f32_32x32x16_bf16 v[112:127], a[200:203], a[148:151], v[112:127]
    v_cvt_pk_bf16_f32 v132, v40, v41
    v_exp_f32 v43, v75
    v_add_f32 v48, v48, v42
    s_waitcnt lgkmcnt(3)
    v_mfma_f32_32x32x16_bf16 a[0:15], a[240:243], v[148:151], a[0:15]
    ds_read_b128 a[208:211], v20 offset:0
    v_exp_f32 v44, v76
    v_add_f32 v48, v48, v43
    v_cvt_pk_bf16_f32 v133, v42, v43
    v_mfma_f32_32x32x16_bf16 a[16:31], a[240:243], v[156:159], a[16:31]
    buffer_load_dwordx4 v12, s[16:19], s31 offen offset:1024 nt lds
    v_exp_f32 v45, v77
    v_add_f32 v48, v48, v44
    s_waitcnt lgkmcnt(3)
    v_mfma_f32_32x32x16_bf16 v[96:111], a[204:207], a[152:155], v[96:111]
    ds_read_b64_tr_b16 a[248:249], v202 offset:12288
    ds_read_b64_tr_b16 a[250:251], v202 offset:14336
    v_exp_f32 v46, v78
    v_add_f32 v48, v48, v45
    v_mfma_f32_32x32x16_bf16 v[112:127], a[204:207], a[156:159], v[112:127]
    v_cvt_pk_bf16_f32 v134, v44, v45
    v_exp_f32 v47, v79
    v_add_f32 v48, v48, v46
    s_waitcnt lgkmcnt(3)
    v_mfma_f32_32x32x16_bf16 a[32:47], a[244:247], v[148:151], a[32:47]
    ds_read_b128 a[212:215], v21 offset:0
    v_exp_f32 v40, v80
    v_add_f32 v48, v48, v47
    v_cvt_pk_bf16_f32 v135, v46, v47
    v_mfma_f32_32x32x16_bf16 a[48:63], a[244:247], v[156:159], a[48:63]
    v_exp_f32 v41, v81
    v_exp_f32 v42, v82
    s_waitcnt lgkmcnt(3)
    v_mfma_f32_32x32x16_bf16 v[96:111], a[208:211], a[160:163], v[96:111]
    ds_read_b128 a[216:219], v22 offset:0
    v_add_f32 v49, v40, v41
    v_cvt_pk_bf16_f32 v136, v40, v41
    v_exp_f32 v43, v83
    v_mfma_f32_32x32x16_bf16 v[112:127], a[208:211], a[164:167], v[112:127]
    v_add_f32 v49, v49, v42
    v_exp_f32 v44, v84
    v_add_f32 v49, v49, v43
    s_waitcnt lgkmcnt(2)
    v_mfma_f32_32x32x16_bf16 a[64:79], a[248:251], v[148:151], a[64:79]
    ds_read_b128 a[220:223], v23 offset:0
    v_cvt_pk_bf16_f32 v137, v42, v43
    v_exp_f32 v45, v85
    v_add_f32 v49, v49, v44
    v_mfma_f32_32x32x16_bf16 a[80:95], a[248:251], v[156:159], a[80:95]
    v_exp_f32 v46, v86
    v_add_f32 v49, v49, v45
    v_cvt_pk_bf16_f32 v138, v44, v45
    s_waitcnt lgkmcnt(2)
    v_mfma_f32_32x32x16_bf16 v[96:111], a[212:215], a[168:171], v[96:111]
    ds_read_b64_tr_b16 a[252:253], v203 offset:12288
    ds_read_b64_tr_b16 a[254:255], v203 offset:14336
    v_exp_f32 v47, v87
    v_add_f32 v49, v49, v46
    v_mfma_f32_32x32x16_bf16 v[112:127], a[212:215], a[172:175], v[112:127]
    v_exp_f32 v40, v88
    v_add_f32 v49, v49, v47
    v_cvt_pk_bf16_f32 v139, v46, v47
    s_waitcnt lgkmcnt(3)
    v_mfma_f32_32x32x16_bf16 v[96:111], a[216:219], a[176:179], v[96:111]
    ds_read_b64_tr_b16 a[224:225], v200 offset:24576
    ds_read_b64_tr_b16 a[226:227], v200 offset:26624
    v_exp_f32 v41, v89
    v_add_f32 v49, v49, v40
    v_mfma_f32_32x32x16_bf16 v[112:127], a[216:219], a[180:183], v[112:127]
    v_exp_f32 v42, v90
    v_add_f32 v49, v49, v41
    v_cvt_pk_bf16_f32 v140, v40, v41
    s_waitcnt lgkmcnt(4)
    v_mfma_f32_32x32x16_bf16 v[96:111], a[220:223], a[184:187], v[96:111]
    ds_read_b64_tr_b16 a[228:229], v201 offset:24576
    ds_read_b64_tr_b16 a[230:231], v201 offset:26624
    v_exp_f32 v43, v91
    v_add_f32 v49, v49, v42
    v_mfma_f32_32x32x16_bf16 v[112:127], a[220:223], a[188:191], v[112:127]
    v_exp_f32 v44, v92
    v_add_f32 v49, v49, v43
    v_cvt_pk_bf16_f32 v141, v42, v43
    s_waitcnt lgkmcnt(4)
    v_mfma_f32_32x32x16_bf16 a[96:111], a[252:255], v[148:151], a[96:111]
    v_exp_f32 v45, v93
    v_add_f32 v49, v49, v44
    v_exp_f32 v46, v94
    v_mfma_f32_32x32x16_bf16 a[112:127], a[252:255], v[156:159], a[112:127]
    v_add_f32 v49, v49, v45
    v_cvt_pk_bf16_f32 v142, v44, v45
    v_exp_f32 v47, v95
    v_add_f32 v49, v49, v46
    s_nop 0
    v_add_f32 v49, v49, v47
    v_cvt_pk_bf16_f32 v143, v46, v47
    v_max_f32 v54, v48, v49
    v_cmp_lt_f32 vcc, s32, v54
    s_cbranch_vccnz F_stub6
F_back6:
    s_waitcnt vmcnt(8)
    s_barrier
    ds_read_b128 a[192:195], v16 offset:16384
    s_waitcnt lgkmcnt(3)
    v_mfma_f32_32x32x16_bf16 a[0:15], a[224:227], v[128:131], a[0:15]
    ds_read_b64_tr_b16 a[232:233], v202 offset:24576
    ds_read_b64_tr_b16 a[234:235], v202 offset:26624
    v_add_f32 v52, v52, v48
    v_add_f32 v53, v53, v49
    v_mfma_f32_32x32x16_bf16 a[16:31], a[224:227], v[136:139], a[16:31]
    v_exp_f32 v40, v96
    v_exp_f32 v41, v97
    s_waitcnt lgkmcnt(3)
    v_mfma_f32_32x32x16_bf16 a[32:47], a[228:231], v[128:131], a[32:47]
    ds_read_b128 a[196:199], v17 offset:16384
    v_exp_f32 v42, v98
    v_add_f32 v50, v40, v41
    v_cvt_pk_bf16_f32 v144, v40, v41
    v_mfma_f32_32x32x16_bf16 a[48:63], a[228:231], v[136:139], a[48:63]
    s_add_u32 m0, s30, 65536
    s_add_u32 s31, s29, 90112
    buffer_load_dwordx4 v10, s[12:15], s31 offen nt lds
    s_waitcnt lgkmcnt(3)
    v_mfma_f32_32x32x16_bf16 v[64:79], a[192:195], a[128:131], v[160:175]
    ds_read_b64_tr_b16 a[236:237], v203 offset:24576
    ds_read_b64_tr_b16 a[238:239], v203 offset:26624
    v_exp_f32 v43, v99
    v_add_f32 v50, v50, v42
    v_mfma_f32_32x32x16_bf16 v[80:95], a[192:195], a[132:135], v[176:191]
    v_exp_f32 v44, v100
    v_add_f32 v50, v50, v43
    v_cvt_pk_bf16_f32 v145, v42, v43
    s_waitcnt lgkmcnt(3)
    v_mfma_f32_32x32x16_bf16 a[64:79], a[232:235], v[128:131], a[64:79]
    ds_read_b128 a[200:203], v18 offset:16384
    v_exp_f32 v45, v101
    v_add_f32 v50, v50, v44
    v_mfma_f32_32x32x16_bf16 a[80:95], a[232:235], v[136:139], a[80:95]
    buffer_load_dwordx4 v11, s[12:15], s31 offen offset:1024 nt lds
    v_exp_f32 v46, v102
    v_add_f32 v50, v50, v45
    s_waitcnt lgkmcnt(3)
    v_mfma_f32_32x32x16_bf16 v[64:79], a[196:199], a[136:139], v[64:79]
    ds_read_b64_tr_b16 a[240:241], v200 offset:28672
    ds_read_b64_tr_b16 a[242:243], v200 offset:30720
    v_cvt_pk_bf16_f32 v146, v44, v45
    v_exp_f32 v47, v103
    v_mfma_f32_32x32x16_bf16 v[80:95], a[196:199], a[140:143], v[80:95]
    v_add_f32 v50, v50, v46
    v_exp_f32 v40, v104
    v_add_f32 v50, v50, v47
    s_waitcnt lgkmcnt(3)
    v_mfma_f32_32x32x16_bf16 a[96:111], a[236:239], v[128:131], a[96:111]
    ds_read_b128 a[204:207], v19 offset:16384
    v_cvt_pk_bf16_f32 v147, v46, v47
    v_exp_f32 v41, v105
    v_add_f32 v50, v50, v40
    v_mfma_f32_32x32x16_bf16 a[112:127], a[236:239], v[136:139], a[112:127]
    s_add_u32 m0, s30, 73728
    s_nop 0
    buffer_load_dwordx4 v12, s[16:19], s31 offen nt lds
    s_waitcnt lgkmcnt(3)
    v_mfma_f32_32x32x16_bf16 v[64:79], a[200:203], a[144:147], v[64:79]
    ds_read_b64_tr_b16 a[244:245], v201 offset:28672
    ds_read_b64_tr_b16 a[246:247], v201 offset:30720
    v_exp_f32 v42, v106
    v_add_f32 v50, v50, v41
    v_mfma_f32_32x32x16_bf16 v[80:95], a[200:203], a[148:151], v[80:95]
    v_cvt_pk_bf16_f32 v148, v40, v41
    v_exp_f32 v43, v107
    v_add_f32 v50, v50, v42
    s_waitcnt lgkmcnt(3)
    v_mfma_f32_32x32x16_bf16 a[0:15], a[240:243], v[132:135], a[0:15]
    ds_read_b128 a[208:211], v20 offset:16384
    v_exp_f32 v44, v108
    v_add_f32 v50, v50, v43
    v_cvt_pk_bf16_f32 v149, v42, v43
    v_mfma_f32_32x32x16_bf16 a[16:31], a[240:243], v[140:143], a[16:31]
    buffer_load_dwordx4 v12, s[16:19], s31 offen offset:1024 nt lds
    v_exp_f32 v45, v109
    v_add_f32 v50, v50, v44
    s_waitcnt lgkmcnt(3)
    v_mfma_f32_32x32x16_bf16 v[64:79], a[204:207], a[152:155], v[64:79]
    ds_read_b64_tr_b16 a[248:249], v202 offset:28672
    ds_read_b64_tr_b16 a[250:251], v202 offset:30720
    v_exp_f32 v46, v110
    v_add_f32 v50, v50, v45
    v_mfma_f32_32x32x16_bf16 v[80:95], a[204:207], a[156:159], v[80:95]
    v_cvt_pk_bf16_f32 v150, v44, v45
    v_exp_f32 v47, v111
    v_add_f32 v50, v50, v46
    s_waitcnt lgkmcnt(3)
    v_mfma_f32_32x32x16_bf16 a[32:47], a[244:247], v[132:135], a[32:47]
    ds_read_b128 a[212:215], v21 offset:16384
    v_exp_f32 v40, v112
    v_add_f32 v50, v50, v47
    v_cvt_pk_bf16_f32 v151, v46, v47
    v_mfma_f32_32x32x16_bf16 a[48:63], a[244:247], v[140:143], a[48:63]
    s_lshl_b32 s34, s28, 9
    s_add_u32 s34, s34, 0x2860000
    v_and_b32 v60, 3, v2
    v_lshlrev_b32 v60, 7, v60
    buffer_load_dwordx2 v[206:207], v60, s[20:23], s34 offen sc1
    s_waitcnt lgkmcnt(3)
    v_mfma_f32_32x32x16_bf16 v[64:79], a[208:211], a[160:163], v[64:79]
    ds_read_b128 a[216:219], v22 offset:16384
    v_exp_f32 v41, v113
    v_exp_f32 v42, v114
    v_mfma_f32_32x32x16_bf16 v[80:95], a[208:211], a[164:167], v[80:95]
    v_add_f32 v51, v40, v41
    v_cvt_pk_bf16_f32 v152, v40, v41
    v_exp_f32 v43, v115
    s_waitcnt lgkmcnt(2)
    v_mfma_f32_32x32x16_bf16 a[64:79], a[248:251], v[132:135], a[64:79]
    ds_read_b128 a[220:223], v23 offset:16384
    v_add_f32 v51, v51, v42
    v_exp_f32 v44, v116
    v_add_f32 v51, v51, v43
    v_mfma_f32_32x32x16_bf16 a[80:95], a[248:251], v[140:143], a[80:95]
    v_cvt_pk_bf16_f32 v153, v42, v43
    v_exp_f32 v45, v117
    v_add_f32 v51, v51, v44
    s_waitcnt lgkmcnt(2)
    v_mfma_f32_32x32x16_bf16 v[64:79], a[212:215], a[168:171], v[64:79]
    ds_read_b64_tr_b16 a[252:253], v203 offset:28672
    ds_read_b64_tr_b16 a[254:255], v203 offset:30720
    v_exp_f32 v46, v118
    v_add_f32 v51, v51, v45
    v_mfma_f32_32x32x16_bf16 v[80:95], a[212:215], a[172:175], v[80:95]
    v_cvt_pk_bf16_f32 v154, v44, v45
    v_exp_f32 v47, v119
    v_add_f32 v51, v51, v46
    s_waitcnt lgkmcnt(3)
    v_mfma_f32_32x32x16_bf16 v[64:79], a[216:219], a[176:179], v[64:79]
    ds_read_b64_tr_b16 a[224:225], v32 offset:8192
    ds_read_b64_tr_b16 a[226:227], v32 offset:10240
    v_exp_f32 v40, v120
    v_add_f32 v51, v51, v47
    v_mfma_f32_32x32x16_bf16 v[80:95], a[216:219], a[180:183], v[80:95]
    v_cvt_pk_bf16_f32 v155, v46, v47
    v_exp_f32 v41, v121
    v_add_f32 v51, v51, v40
    s_waitcnt lgkmcnt(4)
    v_mfma_f32_32x32x16_bf16 v[64:79], a[220:223], a[184:187], v[64:79]
    ds_read_b64_tr_b16 a[228:229], v33 offset:8192
    ds_read_b64_tr_b16 a[230:231], v33 offset:10240
    v_exp_f32 v42, v122
    v_add_f32 v51, v51, v41
    v_mfma_f32_32x32x16_bf16 v[80:95], a[220:223], a[188:191], v[80:95]
    v_cvt_pk_bf16_f32 v156, v40, v41
    v_exp_f32 v43, v123
    v_add_f32 v51, v51, v42
    s_waitcnt lgkmcnt(4)
    v_mfma_f32_32x32x16_bf16 a[96:111], a[252:255], v[132:135], a[96:111]
    v_exp_f32 v44, v124
    v_add_f32 v51, v51, v43
    v_cvt_pk_bf16_f32 v157, v42, v43
    v_mfma_f32_32x32x16_bf16 a[112:127], a[252:255], v[140:143], a[112:127]
    v_exp_f32 v45, v125
    v_add_f32 v51, v51, v44
    v_exp_f32 v46, v126
    v_add_f32 v51, v51, v45
    v_cvt_pk_bf16_f32 v158, v44, v45
    v_exp_f32 v47, v127
    v_add_f32 v51, v51, v46
    s_nop 0
    v_add_f32 v51, v51, v47
    v_cvt_pk_bf16_f32 v159, v46, v47
    v_max_f32 v54, v50, v51
    v_cmp_lt_f32 vcc, s32, v54
    s_cbranch_vccnz F_stub7
F_back7:
    s_waitcnt vmcnt(9)
    s_barrier
    ds_read_b128 a[192:195], v16 offset:32768
    s_waitcnt lgkmcnt(3)
    v_mfma_f32_32x32x16_bf16 a[0:15], a[224:227], v[144:147], a[0:15]
    ds_read_b64_tr_b16 a[232:233], v34 offset:8192
    ds_read_b64_tr_b16 a[234:235], v34 offset:10240
    v_add_f32 v52, v52, v50
    v_add_f32 v53, v53, v51
    v_mfma_f32_32x32x16_bf16 a[16:31], a[224:227], v[152:155], a[16:31]
    v_exp_f32 v40, v64
    v_exp_f32 v41, v65
    s_waitcnt lgkmcnt(3)
    v_mfma_f32_32x32x16_bf16 a[32:47], a[228:231], v[144:147], a[32:47]
    ds_read_b128 a[196:199], v17 offset:32768
    v_exp_f32 v42, v66
    v_add_f32 v48, v40, v41
    v_cvt_pk_bf16_f32 v128, v40, v41
    v_mfma_f32_32x32x16_bf16 a[48:63], a[228:231], v[152:155], a[48:63]
    s_add_u32 m0, s30, 81920
    s_add_u32 s31, s29, 98304
    buffer_load_dwordx4 v10, s[12:15], s31 offen nt lds
    s_waitcnt lgkmcnt(3)
    v_mfma_f32_32x32x16_bf16 v[96:111], a[192:195], a[128:131], v[160:175]
    ds_read_b64_tr_b16 a[236:237], v35 offset:8192
    ds_read_b64_tr_b16 a[238:239], v35 offset:10240
    v_exp_f32 v43, v67
    v_add_f32 v48, v48, v42
    v_mfma_f32_32x32x16_bf16 v[112:127], a[192:195], a[132:135], v[176:191]
    v_exp_f32 v44, v68
    v_add_f32 v48, v48, v43
    v_cvt_pk_bf16_f32 v129, v42, v43
    s_waitcnt lgkmcnt(3)
    v_mfma_f32_32x32x16_bf16 a[64:79], a[232:235], v[144:147], a[64:79]
    ds_read_b128 a[200:203], v18 offset:32768
    v_exp_f32 v45, v69
    v_add_f32 v48, v48, v44
    v_mfma_f32_32x32x16_bf16 a[80:95], a[232:235], v[152:155], a[80:95]
    buffer_load_dwordx4 v11, s[12:15], s31 offen offset:1024 nt lds
    v_exp_f32 v46, v70
    v_add_f32 v48, v48, v45
    s_waitcnt lgkmcnt(3)
    v_mfma_f32_32x32x16_bf16 v[96:111], a[196:199], a[136:139], v[96:111]
    ds_read_b64_tr_b16 a[240:241], v32 offset:12288
    ds_read_b64_tr_b16 a[242:243], v32 offset:14336
    v_cvt_pk_bf16_f32 v130, v44, v45
    v_exp_f32 v47, v71
    v_mfma_f32_32x32x16_bf16 v[112:127], a[196:199], a[140:143], v[112:127]
    v_add_f32 v48, v48, v46
    v_exp_f32 v40, v72
    v_add_f32 v48, v48, v47
    s_waitcnt lgkmcnt(3)
    v_mfma_f32_32x32x16_bf16 a[96:111], a[236:239], v[144:147], a[96:111]
    ds_read_b128 a[204:207], v19 offset:32768
    v_cvt_pk_bf16_f32 v131, v46, v47
    v_exp_f32 v41, v73
    v_add_f32 v48, v48, v40
    v_mfma_f32_32x32x16_bf16 a[112:127], a[236:239], v[152:155], a[112:127]
    s_add_u32 m0, s30, 90112
    s_nop 0
    buffer_load_dwordx4 v12, s[16:19], s31 offen nt lds
    s_waitcnt lgkmcnt(3)
    v_mfma_f32_32x32x16_bf16 v[96:111], a[200:203], a[144:147], v[96:111]
    ds_read_b64_tr_b16 a[244:245], v33 offset:12288
    ds_read_b64_tr_b16 a[246:247], v33 offset:14336
    v_exp_f32 v42, v74
    v_add_f32 v48, v48, v41
    v_mfma_f32_32x32x16_bf16 v[112:127], a[200:203], a[148:151], v[112:127]
    v_cvt_pk_bf16_f32 v132, v40, v41
    v_exp_f32 v43, v75
    v_add_f32 v48, v48, v42
    s_waitcnt lgkmcnt(3)
    v_mfma_f32_32x32x16_bf16 a[0:15], a[240:243], v[148:151], a[0:15]
    ds_read_b128 a[208:211], v20 offset:32768
    v_exp_f32 v44, v76
    v_add_f32 v48, v48, v43
    v_cvt_pk_bf16_f32 v133, v42, v43
    v_mfma_f32_32x32x16_bf16 a[16:31], a[240:243], v[156:159], a[16:31]
    buffer_load_dwordx4 v12, s[16:19], s31 offen offset:1024 nt lds
    v_exp_f32 v45, v77
    v_add_f32 v48, v48, v44
    s_waitcnt lgkmcnt(3)
    v_mfma_f32_32x32x16_bf16 v[96:111], a[204:207], a[152:155], v[96:111]
    ds_read_b64_tr_b16 a[248:249], v34 offset:12288
    ds_read_b64_tr_b16 a[250:251], v34 offset:14336
    v_exp_f32 v46, v78
    v_add_f32 v48, v48, v45
    v_mfma_f32_32x32x16_bf16 v[112:127], a[204:207], a[156:159], v[112:127]
    v_cvt_pk_bf16_f32 v134, v44, v45
    v_exp_f32 v47, v79
    v_add_f32 v48, v48, v46
    s_waitcnt lgkmcnt(3)
    v_mfma_f32_32x32x16_bf16 a[32:47], a[244:247], v[148:151], a[32:47]
    ds_read_b128 a[212:215], v21 offset:32768
    v_exp_f32 v40, v80
    v_add_f32 v48, v48, v47
    v_cvt_pk_bf16_f32 v135, v46, v47
    v_mfma_f32_32x32x16_bf16 a[48:63], a[244:247], v[156:159], a[48:63]
    s_add_u32 s34, s26, 0
    s_and_b32 s34, s34, 7
    s_lshl_b32 s34, s34, 16
    s_add_u32 s34, s34, s52
    s_add_u32 m0, s53, 147456
    s_add_u32 s33, s34, 0
    buffer_load_dwordx4 v205, s[48:51], s33 offen lds
    s_waitcnt lgkmcnt(3)
    v_mfma_f32_32x32x16_bf16 v[96:111], a[208:211], a[160:163], v[96:111]
    ds_read_b128 a[216:219], v22 offset:32768
    v_exp_f32 v41, v81
    v_exp_f32 v42, v82
    v_mfma_f32_32x32x16_bf16 v[112:127], a[208:211], a[164:167], v[112:127]
    v_add_f32 v49, v40, v41
    v_cvt_pk_bf16_f32 v136, v40, v41
    v_exp_f32 v43, v83
    s_waitcnt lgkmcnt(2)
    v_mfma_f32_32x32x16_bf16 a[64:79], a[248:251], v[148:151], a[64:79]
    ds_read_b128 a[220:223], v23 offset:32768
    v_add_f32 v49, v49, v42
    v_exp_f32 v44, v84
    v_add_f32 v49, v49, v43
    v_mfma_f32_32x32x16_bf16 a[80:95], a[248:251], v[156:159], a[80:95]
    s_add_u32 m0, s53, 148480
    s_add_u32 s33, s34, 4096
    buffer_load_dwordx4 v205, s[48:51], s33 offen lds
    v_cvt_pk_bf16_f32 v137, v42, v43
    s_waitcnt lgkmcnt(2)
    v_mfma_f32_32x32x16_bf16 v[96:111], a[212:215], a[168:171], v[96:111]
    ds_read_b64_tr_b16 a[252:253], v35 offset:12288
    ds_read_b64_tr_b16 a[254:255], v35 offset:14336
    v_exp_f32 v45, v85
    v_add_f32 v49, v49, v44
    v_mfma_f32_32x32x16_bf16 v[112:127], a[212:215], a[172:175], v[112:127]
    v_exp_f32 v46, v86
    v_add_f32 v49, v49, v45
    v_cvt_pk_bf16_f32 v138, v44, v45
    s_waitcnt lgkmcnt(3)
    v_mfma_f32_32x32x16_bf16 v[96:111], a[216:219], a[176:179], v[96:111]
    ds_read_b64_tr_b16 a[224:225], v32 offset:24576
    ds_read_b64_tr_b16 a[226:227], v32 offset:26624
    v_exp_f32 v47, v87
    v_add_f32 v49, v49, v46
    v_mfma_f32_32x32x16_bf16 v[112:127], a[216:219], a[180:183], v[112:127]
    s_add_u32 m0, s53, 149504
    s_add_u32 s33, s34, 8192
    buffer_load_dwordx4 v205, s[48:51], s33 offen lds
    s_waitcnt lgkmcnt(4)
    v_mfma_f32_32x32x16_bf16 v[96:111], a[220:223], a[184:187], v[96:111]
    ds_read_b64_tr_b16 a[228:229], v33 offset:24576
    ds_read_b64_tr_b16 a[230:231], v33 offset:26624
    v_exp_f32 v40, v88
    v_add_f32 v49, v49, v47
    v_mfma_f32_32x32x16_bf16 v[112:127], a[220:223], a[188:191], v[112:127]
    v_cvt_pk_bf16_f32 v139, v46, v47
    v_exp_f32 v41, v89
    v_add_f32 v49, v49, v40
    s_waitcnt lgkmcnt(4)
    v_mfma_f32_32x32x16_bf16 a[96:111], a[252:255], v[148:151], a[96:111]
    v_exp_f32 v42, v90
    v_add_f32 v49, v49, v41
    v_cvt_pk_bf16_f32 v140, v40, v41
    v_mfma_f32_32x32x16_bf16 a[112:127], a[252:255], v[156:159], a[112:127]
    s_add_u32 m0, s53, 150528
    s_add_u32 s33, s34, 12288
    buffer_load_dwordx4 v205, s[48:51], s33 offen lds
    v_exp_f32 v43, v91
    v_add_f32 v49, v49, v42
    v_exp_f32 v44, v92
    v_add_f32 v49, v49, v43
    v_cvt_pk_bf16_f32 v141, v42, v43
    v_exp_f32 v45, v93
    v_add_f32 v49, v49, v44
    v_exp_f32 v46, v94
    v_add_f32 v49, v49, v45
    v_cvt_pk_bf16_f32 v142, v44, v45
    v_exp_f32 v47, v95
    v_add_f32 v49, v49, v46
    s_nop 0
    v_add_f32 v49, v49, v47
    v_cvt_pk_bf16_f32 v143, v46, v47
    v_max_f32 v54, v48, v49
    v_cmp_lt_f32 vcc, s32, v54
    s_cbranch_vccnz F_stub8
F_back8:
    s_waitcnt vmcnt(13)
    s_barrier
    ds_read_b128 a[192:195], v16 offset:49152
    s_waitcnt lgkmcnt(3)
    v_mfma_f32_32x32x16_bf16 a[0:15], a[224:227], v[128:131], a[0:15]
    ds_read_b64_tr_b16 a[232:233], v34 offset:24576
    ds_read_b64_tr_b16 a[234:235], v34 offset:26624
    v_add_f32 v52, v52, v48
    v_add_f32 v53, v53, v49
    v_mfma_f32_32x32x16_bf16 a[16:31], a[224:227], v[136:139], a[16:31]
    v_exp_f32 v40, v96
    v_exp_f32 v41, v97
    s_waitcnt lgkmcnt(3)
    v_mfma_f32_32x32x16_bf16 a[32:47], a[228:231], v[128:131], a[32:47]
    ds_read_b128 a[196:199], v17 offset:49152
    v_exp_f32 v42, v98
    v_add_f32 v50, v40, v41
    v_cvt_pk_bf16_f32 v144, v40, v41
    v_mfma_f32_32x32x16_bf16 a[48:63], a[228:231], v[136:139], a[48:63]
    s_add_u32 m0, s30, 98304
    s_add_u32 s31, s29, 106496
    buffer_load_dwordx4 v10, s[12:15], s31 offen nt lds
    s_waitcnt lgkmcnt(3)
    v_mfma_f32_32x32x16_bf16 v[64:79], a[192:195], a[128:131], v[160:175]
    ds_read_b64_tr_b16 a[236:237], v35 offset:24576
    ds_read_b64_tr_b16 a[238:239], v35 offset:26624
    v_exp_f32 v43, v99
    v_add_f32 v50, v50, v42
    v_mfma_f32_32x32x16_bf16 v[80:95], a[192:195], a[132:135], v[176:191]
    v_exp_f32 v44, v100
    v_add_f32 v50, v50, v43
    v_cvt_pk_bf16_f32 v145, v42, v43
    s_waitcnt lgkmcnt(3)
    v_mfma_f32_32x32x16_bf16 a[64:79], a[232:235], v[128:131], a[64:79]
    ds_read_b128 a[200:203], v18 offset:49152
    v_exp_f32 v45, v101
    v_add_f32 v50, v50, v44
    v_mfma_f32_32x32x16_bf16 a[80:95], a[232:235], v[136:139], a[80:95]
    buffer_load_dwordx4 v11, s[12:15], s31 offen offset:1024 nt lds
    v_exp_f32 v46, v102
    v_add_f32 v50, v50, v45
    s_waitcnt lgkmcnt(3)
    v_mfma_f32_32x32x16_bf16 v[64:79], a[196:199], a[136:139], v[64:79]
    ds_read_b64_tr_b16 a[240:241], v32 offset:28672
    ds_read_b64_tr_b16 a[242:243], v32 offset:30720
    v_cvt_pk_bf16_f32 v146, v44, v45
    v_exp_f32 v47, v103
    v_mfma_f32_32x32x16_bf16 v[80:95], a[196:199], a[140:143], v[80:95]
    v_add_f32 v50, v50, v46
    v_exp_f32 v40, v104
    v_add_f32 v50, v50, v47
    s_waitcnt lgkmcnt(3)
    v_mfma_f32_32x32x16_bf16 a[96:111], a[236:239], v[128:131], a[96:111]
    ds_read_b128 a[204:207], v19 offset:49152
    v_cvt_pk_bf16_f32 v147, v46, v47
    v_exp_f32 v41, v105
    v_add_f32 v50, v50, v40
    v_mfma_f32_32x32x16_bf16 a[112:127], a[236:239], v[136:139], a[112:127]
    s_add_u32 m0, s30, 106496
    s_nop 0
    buffer_load_dwordx4 v12, s[16:19], s31 offen nt lds
    s_waitcnt lgkmcnt(3)
    v_mfma_f32_32x32x16_bf16 v[64:79], a[200:203], a[144:147], v[64:79]
    ds_read_b64_tr_b16 a[244:245], v33 offset:28672
    ds_read_b64_tr_b16 a[246:247], v33 offset:30720
    v_exp_f32 v42, v106
    v_add_f32 v50, v50, v41
    v_mfma_f32_32x32x16_bf16 v[80:95], a[200:203], a[148:151], v[80:95]
    v_cvt_pk_bf16_f32 v148, v40, v41
    v_exp_f32 v43, v107
    v_add_f32 v50, v50, v42
    s_waitcnt lgkmcnt(3)
    v_mfma_f32_32x32x16_bf16 a[0:15], a[240:243], v[132:135], a[0:15]
    ds_read_b128 a[208:211], v20 offset:49152
    v_exp_f32 v44, v108
    v_add_f32 v50, v50, v43
    v_cvt_pk_bf16_f32 v149, v42, v43
    v_mfma_f32_32x32x16_bf16 a[16:31], a[240:243], v[140:143], a[16:31]
    buffer_load_dwordx4 v12, s[16:19], s31 offen offset:1024 nt lds
    v_exp_f32 v45, v109
    v_add_f32 v50, v50, v44
    s_waitcnt lgkmcnt(3)
    v_mfma_f32_32x32x16_bf16 v[64:79], a[204:207], a[152:155], v[64:79]
    ds_read_b64_tr_b16 a[248:249], v34 offset:28672
    ds_read_b64_tr_b16 a[250:251], v34 offset:30720
    v_exp_f32 v46, v110
    v_add_f32 v50, v50, v45
    v_mfma_f32_32x32x16_bf16 v[80:95], a[204:207], a[156:159], v[80:95]
    v_cvt_pk_bf16_f32 v150, v44, v45
    v_exp_f32 v47, v111
    v_add_f32 v50, v50, v46
    s_waitcnt lgkmcnt(3)
    v_mfma_f32_32x32x16_bf16 a[32:47], a[244:247], v[132:135], a[32:47]
    ds_read_b128 a[212:215], v21 offset:49152
    v_exp_f32 v40, v112
    v_add_f32 v50, v50, v47
    v_cvt_pk_bf16_f32 v151, v46, v47
    v_mfma_f32_32x32x16_bf16 a[48:63], a[244:247], v[140:143], a[48:63]
    s_add_u32 s34, s26, 1
    s_and_b32 s34, s34, 7
    s_lshl_b32 s34, s34, 16
    s_add_u32 s34, s34, s52
    s_add_u32 m0, s53, 0
    s_add_u32 s33, s34, 0
    buffer_load_dwordx4 v205, s[48:51], s33 offen lds
    s_waitcnt lgkmcnt(3)
    v_mfma_f32_32x32x16_bf16 v[64:79], a[208:211], a[160:163], v[64:79]
    ds_read_b128 a[216:219], v22 offset:49152
    v_exp_f32 v41, v113
    v_exp_f32 v42, v114
    v_mfma_f32_32x32x16_bf16 v[80:95], a[208:211], a[164:167], v[80:95]
    v_add_f32 v51, v40, v41
    v_cvt_pk_bf16_f32 v152, v40, v41
    v_exp_f32 v43, v115
    s_waitcnt lgkmcnt(2)
    v_mfma_f32_32x32x16_bf16 a[64:79], a[248:251], v[132:135], a[64:79]
    ds_read_b128 a[220:223], v23 offset:49152
    v_add_f32 v51, v51, v42
    v_exp_f32 v44, v116
    v_add_f32 v51, v51, v43
    v_mfma_f32_32x32x16_bf16 a[80:95], a[248:251], v[140:143], a[80:95]
    s_add_u32 m0, s53, 1024
    s_add_u32 s33, s34, 4096
    buffer_load_dwordx4 v205, s[48:51], s33 offen lds
    v_cvt_pk_bf16_f32 v153, v42, v43
    s_waitcnt lgkmcnt(2)
    v_mfma_f32_32x32x16_bf16 v[64:79], a[212:215], a[168:171], v[64:79]
    ds_read_b64_tr_b16 a[252:253], v35 offset:28672
    ds_read_b64_tr_b16 a[254:255], v35 offset:30720
    v_exp_f32 v45, v117
    v_add_f32 v51, v51, v44
    v_mfma_f32_32x32x16_bf16 v[80:95], a[212:215], a[172:175], v[80:95]
    v_exp_f32 v46, v118
    v_add_f32 v51, v51, v45
    v_cvt_pk_bf16_f32 v154, v44, v45
    s_waitcnt lgkmcnt(3)
    v_mfma_f32_32x32x16_bf16 v[64:79], a[216:219], a[176:179], v[64:79]
    ds_read_b64_tr_b16 a[224:225], v32 offset:40960
    ds_read_b64_tr_b16 a[226:227], v32 offset:43008
    v_exp_f32 v47, v119
    v_add_f32 v51, v51, v46
    v_mfma_f32_32x32x16_bf16 v[80:95], a[216:219], a[180:183], v[80:95]
    s_add_u32 m0, s53, 2048
    s_add_u32 s33, s34, 8192
    buffer_load_dwordx4 v205, s[48:51], s33 offen lds
    s_waitcnt lgkmcnt(4)
    v_mfma_f32_32x32x16_bf16 v[64:79], a[220:223], a[184:187], v[64:79]
    ds_read_b64_tr_b16 a[228:229], v33 offset:40960
    ds_read_b64_tr_b16 a[230:231], v33 offset:43008
    v_exp_f32 v40, v120
    v_add_f32 v51, v51, v47
    v_mfma_f32_32x32x16_bf16 v[80:95], a[220:223], a[188:191], v[80:95]
    v_cvt_pk_bf16_f32 v155, v46, v47
    v_exp_f32 v41, v121
    v_add_f32 v51, v51, v40
    s_waitcnt lgkmcnt(4)
    v_mfma_f32_32x32x16_bf16 a[96:111], a[252:255], v[132:135], a[96:111]
    v_exp_f32 v42, v122
    v_add_f32 v51, v51, v41
    v_cvt_pk_bf16_f32 v156, v40, v41
    v_mfma_f32_32x32x16_bf16 a[112:127], a[252:255], v[140:143], a[112:127]
    s_add_u32 m0, s53, 3072
    s_add_u32 s33, s34, 12288
    buffer_load_dwordx4 v205, s[48:51], s33 offen lds
    v_exp_f32 v43, v123
    v_add_f32 v51, v51, v42
    v_exp_f32 v44, v124
    v_add_f32 v51, v51, v43
    v_cvt_pk_bf16_f32 v157, v42, v43
    v_exp_f32 v45, v125
    v_add_f32 v51, v51, v44
    v_exp_f32 v46, v126
    v_add_f32 v51, v51, v45
    v_cvt_pk_bf16_f32 v158, v44, v45
    v_exp_f32 v47, v127
    v_add_f32 v51, v51, v46
    s_nop 0
    v_add_f32 v51, v51, v47
    v_cvt_pk_bf16_f32 v159, v46, v47
    v_max_f32 v54, v50, v51
    v_cmp_lt_f32 vcc, s32, v54
    s_mov_b64 s[40:41], vcc
    s_waitcnt vmcnt(16)
    s_cmp_eq_u32 s24, 0
    s_cbranch_scc0 F_qd_ok
F_qd_again:
    v_cmp_eq_u32 vcc, s38, v206
    v_cmp_eq_u32 s[46:47], s39, v207
    s_nop 2
    s_and_b64 vcc, vcc, s[46:47]
    s_cmp_eq_u64 vcc, -1
    s_cbranch_scc1 F_qd_ok
    s_add_u32 s69, s69, 1
    s_cmp_lt_u32 s69, 300000
    s_cbranch_scc0 F_qd_ok
    s_lshl_b32 s34, s28, 9
    s_add_u32 s34, s34, 0x2860000
    v_and_b32 v60, 3, v2
    v_lshlrev_b32 v60, 7, v60
    buffer_load_dwordx2 v[206:207], v60, s[20:23], s34 offen sc1
    s_waitcnt vmcnt(0)
    s_branch F_qd_again
F_qd_ok:
    s_mov_b64 vcc, s[40:41]
    s_cbranch_vccnz F_stub9
F_back9:
    s_barrier
    ds_read_b128 a[192:195], v24 offset:0
    s_waitcnt lgkmcnt(3)
    v_mfma_f32_32x32x16_bf16 a[0:15], a[224:227], v[144:147], a[0:15]
    ds_read_b64_tr_b16 a[232:233], v34 offset:40960
    ds_read_b64_tr_b16 a[234:235], v34 offset:43008
    v_add_f32 v52, v52, v50
    v_add_f32 v53, v53, v51
    v_mfma_f32_32x32x16_bf16 a[16:31], a[224:227], v[152:155], a[16:31]
    v_exp_f32 v40, v64
    v_exp_f32 v41, v65
    s_waitcnt lgkmcnt(3)
    v_mfma_f32_32x32x16_bf16 a[32:47], a[228:231], v[144:147], a[32:47]
    ds_read_b128 a[196:199], v25 offset:0
    v_exp_f32 v42, v66
    v_add_f32 v48, v40, v41
    v_cvt_pk_bf16_f32 v128, v40, v41
    v_mfma_f32_32x32x16_bf16 a[48:63], a[228:231], v[152:155], a[48:63]
    s_add_u32 m0, s30, 114688
    s_add_u32 s31, s29, 114688
    buffer_load_dwordx4 v10, s[12:15], s31 offen nt lds
    s_waitcnt lgkmcnt(3)
    v_mfma_f32_32x32x16_bf16 v[96:111], a[192:195], a[128:131], v[160:175]
    ds_read_b64_tr_b16 a[236:237], v35 offset:40960
    ds_read_b64_tr_b16 a[238:239], v35 offset:43008
    v_exp_f32 v43, v67
    v_add_f32 v48, v48, v42
    v_mfma_f32_32x32x16_bf16 v[112:127], a[192:195], a[132:135], v[176:191]
    v_exp_f32 v44, v68
    v_add_f32 v48, v48, v43
    v_cvt_pk_bf16_f32 v129, v42, v43
    s_waitcnt lgkmcnt(3)
    v_mfma_f32_32x32x16_bf16 a[64:79], a[232:235], v[144:147], a[64:79]
    ds_read_b128 a[200:203], v26 offset:0
    v_exp_f32 v45, v69
    v_add_f32 v48, v48, v44
    v_mfma_f32_32x32x16_bf16 a[80:95], a[232:235], v[152:155], a[80:95]
    buffer_load_dwordx4 v11, s[12:15], s31 offen offset:1024 nt lds
    v_exp_f32 v46, v70
    v_add_f32 v48, v48, v45
    s_waitcnt lgkmcnt(3)
    v_mfma_f32_32x32x16_bf16 v[96:111], a[196:199], a[136:139], v[96:111]
    ds_read_b64_tr_b16 a[240:241], v32 offset:45056
    ds_read_b64_tr_b16 a[242:243], v32 offset:47104
    v_cvt_pk_bf16_f32 v130, v44, v45
    v_exp_f32 v47, v71
    v_mfma_f32_32x32x16_bf16 v[112:127], a[196:199], a[140:143], v[112:127]
    v_add_f32 v48, v48, v46
    v_exp_f32 v40, v72
    v_add_f32 v48, v48, v47
    s_waitcnt lgkmcnt(3)
    v_mfma_f32_32x32x16_bf16 a[96:111], a[236:239], v[144:147], a[96:111]
    ds_read_b128 a[204:207], v27 offset:0
    v_cvt_pk_bf16_f32 v131, v46, v47
    v_exp_f32 v41, v73
    v_add_f32 v48, v48, v40
    v_mfma_f32_32x32x16_bf16 a[112:127], a[236:239], v[152:155], a[112:127]
    s_add_u32 m0, s30, 122880
    s_nop 0
    buffer_load_dwordx4 v12, s[16:19], s31 offen nt lds
    s_waitcnt lgkmcnt(3)
    v_mfma_f32_32x32x16_bf16 v[96:111], a[200:203], a[144:147], v[96:111]
    ds_read_b64_tr_b16 a[244:245], v33 offset:45056
    ds_read_b64_tr_b16 a[246:247], v33 offset:47104
    v_exp_f32 v42, v74
    v_add_f32 v48, v48, v41
    v_mfma_f32_32x32x16_bf16 v[112:127], a[200:203], a[148:151], v[112:127]
    v_cvt_pk_bf16_f32 v132, v40, v41
    v_exp_f32 v43, v75
    v_add_f32 v48, v48, v42
    s_waitcnt lgkmcnt(3)
    v_mfma_f32_32x32x16_bf16 a[0:15], a[240:243], v[148:151], a[0:15]
    ds_read_b128 a[208:211], v28 offset:0
    v_exp_f32 v44, v76
    v_add_f32 v48, v48, v43
    v_cvt_pk_bf16_f32 v133, v42, v43
    v_mfma_f32_32x32x16_bf16 a[16:31], a[240:243], v[156:159], a[16:31]
    buffer_load_dwordx4 v12, s[16:19], s31 offen offset:1024 nt lds
    v_exp_f32 v45, v77
    v_add_f32 v48, v48, v44
    s_waitcnt lgkmcnt(3)
    v_mfma_f32_32x32x16_bf16 v[96:111], a[204:207], a[152:155], v[96:111]
    ds_read_b64_tr_b16 a[248:249], v34 offset:45056
    ds_read_b64_tr_b16 a[250:251], v34 offset:47104
    v_exp_f32 v46, v78
    v_add_f32 v48, v48, v45
    v_mfma_f32_32x32x16_bf16 v[112:127], a[204:207], a[156:159], v[112:127]
    v_cvt_pk_bf16_f32 v134, v44, v45
    v_exp_f32 v47, v79
    v_add_f32 v48, v48, v46
    s_waitcnt lgkmcnt(3)
    v_mfma_f32_32x32x16_bf16 a[32:47], a[244:247], v[148:151], a[32:47]
    ds_read_b128 a[212:215], v29 offset:0
    v_exp_f32 v40, v80
    v_add_f32 v48, v48, v47
    v_cvt_pk_bf16_f32 v135, v46, v47
    v_mfma_f32_32x32x16_bf16 a[48:63], a[244:247], v[156:159], a[48:63]
    s_add_u32 s34, s26, 2
    s_and_b32 s34, s34, 7
    s_lshl_b32 s34, s34, 16
    s_add_u32 s34, s34, s52
    s_add_u32 m0, s53, 16384
    s_add_u32 s33, s34, 0
    buffer_load_dwordx4 v205, s[48:51], s33 offen lds
    s_waitcnt lgkmcnt(3)
    v_mfma_f32_32x32x16_bf16 v[96:111], a[208:211], a[160:163], v[96:111]
    ds_read_b128 a[216:219], v30 offset:0
    v_exp_f32 v41, v81
    v_exp_f32 v42, v82
    v_mfma_f32_32x32x16_bf16 v[112:127], a[208:211], a[164:167], v[112:127]
    v_add_f32 v49, v40, v41
    v_cvt_pk_bf16_f32 v136, v40, v41
    v_exp_f32 v43, v83
    s_waitcnt lgkmcnt(2)
    v_mfma_f32_32x32x16_bf16 a[64:79], a[248:251], v[148:151], a[64:79]
    ds_read_b128 a[220:223], v31 offset:0
    v_add_f32 v49, v49, v42
    v_exp_f32 v44, v84
    v_add_f32 v49, v49, v43
    v_mfma_f32_32x32x16_bf16 a[80:95], a[248:251], v[156:159], a[80:95]
    s_add_u32 m0, s53, 17408
    s_add_u32 s33, s34, 4096
    buffer_load_dwordx4 v205, s[48:51], s33 offen lds
    v_cvt_pk_bf16_f32 v137, v42, v43
    s_waitcnt lgkmcnt(2)
    v_mfma_f32_32x32x16_bf16 v[96:111], a[212:215], a[168:171], v[96:111]
    ds_read_b64_tr_b16 a[252:253], v35 offset:45056
    ds_read_b64_tr_b16 a[254:255], v35 offset:47104
    v_exp_f32 v45, v85
    v_add_f32 v49, v49, v44
    v_mfma_f32_32x32x16_bf16 v[112:127], a[212:215], a[172:175], v[112:127]
    v_exp_f32 v46, v86
    v_add_f32 v49, v49, v45
    v_cvt_pk_bf16_f32 v138, v44, v45
    s_waitcnt lgkmcnt(3)
    v_mfma_f32_32x32x16_bf16 v[96:111], a[216:219], a[176:179], v[96:111]
    ds_read_b64_tr_b16 a[224:225], v32 offset:57344
    ds_read_b64_tr_b16 a[226:227], v32 offset:59392
    v_exp_f32 v47, v87
    v_add_f32 v49, v49, v46
    v_mfma_f32_32x32x16_bf16 v[112:127], a[216:219], a[180:183], v[112:127]
    s_add_u32 m0, s53, 18432
    s_add_u32 s33, s34, 8192
    buffer_load_dwordx4 v205, s[48:51], s33 offen lds
    s_waitcnt lgkmcnt(4)
    v_mfma_f32_32x32x16_bf16 v[96:111], a[220:223], a[184:187], v[96:111]
    ds_read_b64_tr_b16 a[228:229], v33 offset:57344
    ds_read_b64_tr_b16 a[230:231], v33 offset:59392
    v_exp_f32 v40, v88
    v_add_f32 v49, v49, v47
    v_mfma_f32_32x32x16_bf16 v[112:127], a[220:223], a[188:191], v[112:127]
    v_cvt_pk_bf16_f32 v139, v46, v47
    v_exp_f32 v41, v89
    v_add_f32 v49, v49, v40
    s_waitcnt lgkmcnt(4)
    v_mfma_f32_32x32x16_bf16 a[96:111], a[252:255], v[148:151], a[96:111]
    v_exp_f32 v42, v90
    v_add_f32 v49, v49, v41
    v_cvt_pk_bf16_f32 v140, v40, v41
    v_mfma_f32_32x32x16_bf16 a[112:127], a[252:255], v[156:159], a[112:127]
    s_add_u32 m0, s53, 19456
    s_add_u32 s33, s34, 12288
    buffer_load_dwordx4 v205, s[48:51], s33 offen lds
    v_exp_f32 v43, v91
    v_add_f32 v49, v49, v42
    v_exp_f32 v44, v92
    v_add_f32 v49, v49, v43
    v_cvt_pk_bf16_f32 v141, v42, v43
    v_exp_f32 v45, v93
    v_add_f32 v49, v49, v44
    v_exp_f32 v46, v94
    v_add_f32 v49, v49, v45
    v_cvt_pk_bf16_f32 v142, v44, v45
    v_exp_f32 v47, v95
    v_add_f32 v49, v49, v46
    s_nop 0
    v_add_f32 v49, v49, v47
    v_cvt_pk_bf16_f32 v143, v46, v47
    v_max_f32 v54, v48, v49
    v_cmp_lt_f32 vcc, s32, v54
    s_cbranch_vccnz F_stub10
F_back10:
    s_waitcnt vmcnt(20)
    s_barrier
    ds_read_b128 a[192:195], v24 offset:16384
    s_waitcnt lgkmcnt(3)
    v_mfma_f32_32x32x16_bf16 a[0:15], a[224:227], v[128:131], a[0:15]
    ds_read_b64_tr_b16 a[232:233], v34 offset:57344
    ds_read_b64_tr_b16 a[234:235], v34 offset:59392
    v_add_f32 v52, v52, v48
    v_add_f32 v53, v53, v49
    v_mfma_f32_32x32x16_bf16 a[16:31], a[224:227], v[136:139], a[16:31]
    v_exp_f32 v40, v96
    v_exp_f32 v41, v97
    s_waitcnt lgkmcnt(3)
    v_mfma_f32_32x32x16_bf16 a[32:47], a[228:231], v[128:131], a[32:47]
    ds_read_b128 a[196:199], v25 offset:16384
    v_exp_f32 v42, v98
    v_add_f32 v50, v40, v41
    v_cvt_pk_bf16_f32 v144, v40, v41
    v_mfma_f32_32x32x16_bf16 a[48:63], a[228:231], v[136:139], a[48:63]
    s_add_u32 m0, s30, 131072
    s_add_u32 s31, s29, 122880
    buffer_load_dwordx4 v10, s[12:15], s31 offen nt lds
    s_waitcnt lgkmcnt(3)
    v_mfma_f32_32x32x16_bf16 v[64:79], a[192:195], a[128:131], v[160:175]
    ds_read_b64_tr_b16 a[236:237], v35 offset:57344
    ds_read_b64_tr_b16 a[238:239], v35 offset:59392
    v_exp_f32 v43, v99
    v_add_f32 v50, v50, v42
    v_mfma_f32_32x32x16_bf16 v[80:95], a[192:195], a[132:135], v[176:191]
    buffer_load_dwordx4 v11, s[12:15], s31 offen offset:1024 nt lds
    v_exp_f32 v44, v100
    v_add_f32 v50, v50, v43
    s_waitcnt lgkmcnt(3)
    v_mfma_f32_32x32x16_bf16 a[64:79], a[232:235], v[128:131], a[64:79]
    ds_read_b128 a[200:203], v26 offset:16384
    v_cvt_pk_bf16_f32 v145, v42, v43
    v_exp_f32 v45, v101
    v_add_f32 v50, v50, v44
    v_mfma_f32_32x32x16_bf16 a[80:95], a[232:235], v[136:139], a[80:95]
    s_add_u32 m0, s30, 139264
    s_nop 0
    buffer_load_dwordx4 v12, s[16:19], s31 offen nt lds
    s_waitcnt lgkmcnt(3)
    v_mfma_f32_32x32x16_bf16 v[64:79], a[196:199], a[136:139], v[64:79]
    ds_read_b64_tr_b16 a[240:241], v32 offset:61440
    ds_read_b64_tr_b16 a[242:243], v32 offset:63488
    v_exp_f32 v46, v102
    v_add_f32 v50, v50, v45
    v_mfma_f32_32x32x16_bf16 v[80:95], a[196:199], a[140:143], v[80:95]
    v_cvt_pk_bf16_f32 v146, v44, v45
    v_exp_f32 v47, v103
    v_add_f32 v50, v50, v46
    s_waitcnt lgkmcnt(3)
    v_mfma_f32_32x32x16_bf16 a[96:111], a[236:239], v[128:131], a[96:111]
    ds_read_b128 a[204:207], v27 offset:16384
    v_exp_f32 v40, v104
    v_add_f32 v50, v50, v47
    v_cvt_pk_bf16_f32 v147, v46, v47
    v_mfma_f32_32x32x16_bf16 a[112:127], a[236:239], v[136:139], a[112:127]
    buffer_load_dwordx4 v12, s[16:19], s31 offen offset:1024 nt lds
    v_exp_f32 v41, v105
    v_add_f32 v50, v50, v40
    s_waitcnt lgkmcnt(3)
    v_mfma_f32_32x32x16_bf16 v[64:79], a[200:203], a[144:147], v[64:79]
    ds_read_b64_tr_b16 a[244:245], v33 offset:61440
    ds_read_b64_tr_b16 a[246:247], v33 offset:63488
    v_exp_f32 v42, v106
    v_add_f32 v50, v50, v41
    v_mfma_f32_32x32x16_bf16 v[80:95], a[200:203], a[148:151], v[80:95]
    v_cvt_pk_bf16_f32 v148, v40, v41
    v_exp_f32 v43, v107
    v_add_f32 v50, v50, v42
    s_waitcnt lgkmcnt(3)
    v_mfma_f32_32x32x16_bf16 a[0:15], a[240:243], v[132:135], a[0:15]
    ds_read_b128 a[208:211], v28 offset:16384
    v_exp_f32 v44, v108
    v_add_f32 v50, v50, v43
    v_cvt_pk_bf16_f32 v149, v42, v43
    v_mfma_f32_32x32x16_bf16 a[16:31], a[240:243], v[140:143], a[16:31]
    s_cmp_eq_u32 s24, s27
    s_cbranch_scc1 F_pt_skip0
    s_sub_u32 s35, s27, s24
    s_and_b32 s35, s35, 3
    s_cmp_lt_u32 s35, 3
    s_cbranch_scc1 F_pt_skip0
    s_lshl_b32 s35, s28, 2
    s_add_u32 s35, s35, s24
    s_lshl_b32 s35, s35, 2
    s_add_u32 s35, s35, s27
    s_mul_i32 s35, s35, 0x4400
    s_add_u32 s35, s35, 0x800000
    v_and_b32 v60, 31, v2
    v_lshlrev_b32 v60, 7, v60
    buffer_load_dword v61, v60, s[20:23], s35 offen
F_pt_skip0:
    s_waitcnt lgkmcnt(3)
    v_mfma_f32_32x32x16_bf16 v[64:79], a[204:207], a[152:155], v[64:79]
    ds_read_b64_tr_b16 a[248:249], v34 offset:61440
    ds_read_b64_tr_b16 a[250:251], v34 offset:63488
    v_exp_f32 v45, v109
    v_add_f32 v50, v50, v44
    v_mfma_f32_32x32x16_bf16 v[80:95], a[204:207], a[156:159], v[80:95]
    v_exp_f32 v46, v110
    v_add_f32 v50, v50, v45
    v_cvt_pk_bf16_f32 v150, v44, v45
    s_waitcnt lgkmcnt(3)
    v_mfma_f32_32x32x16_bf16 a[32:47], a[244:247], v[132:135], a[32:47]
    ds_read_b128 a[212:215], v29 offset:16384
    v_exp_f32 v47, v111
    v_add_f32 v50, v50, v46
    v_mfma_f32_32x32x16_bf16 a[48:63], a[244:247], v[140:143], a[48:63]
    s_add_u32 s34, s26, 3
    s_and_b32 s34, s34, 7
    s_lshl_b32 s34, s34, 16
    s_add_u32 s34, s34, s52
    s_add_u32 m0, s53, 32768
    s_add_u32 s33, s34, 0
    buffer_load_dwordx4 v205, s[48:51], s33 offen lds
    s_waitcnt lgkmcnt(3)
    v_mfma_f32_32x32x16_bf16 v[64:79], a[208:211], a[160:163], v[64:79]
    ds_read_b128 a[216:219], v30 offset:16384
    v_exp_f32 v40, v112
    v_add_f32 v50, v50, v47
    v_cvt_pk_bf16_f32 v151, v46, v47
    v_mfma_f32_32x32x16_bf16 v[80:95], a[208:211], a[164:167], v[80:95]
    v_exp_f32 v41, v113
    v_exp_f32 v42, v114
    s_waitcnt lgkmcnt(2)
    v_mfma_f32_32x32x16_bf16 a[64:79], a[248:251], v[132:135], a[64:79]
    ds_read_b128 a[220:223], v31 offset:16384
    v_add_f32 v51, v40, v41
    v_cvt_pk_bf16_f32 v152, v40, v41
    v_exp_f32 v43, v115
    v_mfma_f32_32x32x16_bf16 a[80:95], a[248:251], v[140:143], a[80:95]
    s_add_u32 m0, s53, 33792
    s_add_u32 s33, s34, 4096
    buffer_load_dwordx4 v205, s[48:51], s33 offen lds
    v_add_f32 v51, v51, v42
    s_waitcnt lgkmcnt(2)
    v_mfma_f32_32x32x16_bf16 v[64:79], a[212:215], a[168:171], v[64:79]
    ds_read_b64_tr_b16 a[252:253], v35 offset:61440
    ds_read_b64_tr_b16 a[254:255], v35 offset:63488
    v_exp_f32 v44, v116
    v_add_f32 v51, v51, v43
    v_mfma_f32_32x32x16_bf16 v[80:95], a[212:215], a[172:175], v[80:95]
    v_cvt_pk_bf16_f32 v153, v42, v43
    v_exp_f32 v45, v117
    v_add_f32 v51, v51, v44
    s_waitcnt lgkmcnt(3)
    v_mfma_f32_32x32x16_bf16 v[64:79], a[216:219], a[176:179], v[64:79]
    ds_read_b64_tr_b16 a[224:225], v36 offset:8192
    ds_read_b64_tr_b16 a[226:227], v36 offset:10240
    v_exp_f32 v46, v118
    v_add_f32 v51, v51, v45
    v_mfma_f32_32x32x16_bf16 v[80:95], a[216:219], a[180:183], v[80:95]
    s_add_u32 m0, s53, 34816
    s_add_u32 s33, s34, 8192
    buffer_load_dwordx4 v205, s[48:51], s33 offen lds
    v_cvt_pk_bf16_f32 v154, v44, v45
    s_waitcnt lgkmcnt(4)
    v_mfma_f32_32x32x16_bf16 v[64:79], a[220:223], a[184:187], v[64:79]
    ds_read_b64_tr_b16 a[228:229], v37 offset:8192
    ds_read_b64_tr_b16 a[230:231], v37 offset:10240
    v_exp_f32 v47, v119
    v_add_f32 v51, v51, v46
    v_mfma_f32_32x32x16_bf16 v[80:95], a[220:223], a[188:191], v[80:95]
    v_exp_f32 v40, v120
    v_add_f32 v51, v51, v47
    v_cvt_pk_bf16_f32 v155, v46, v47
    s_waitcnt lgkmcnt(4)
    v_mfma_f32_32x32x16_bf16 a[96:111], a[252:255], v[132:135], a[96:111]
    v_exp_f32 v41, v121
    v_add_f32 v51, v51, v40
    v_exp_f32 v42, v122
    v_mfma_f32_32x32x16_bf16 a[112:127], a[252:255], v[140:143], a[112:127]
    s_add_u32 m0, s53, 35840
    s_add_u32 s33, s34, 12288
    buffer_load_dwordx4 v205, s[48:51], s33 offen lds
    v_add_f32 v51, v51, v41
    v_cvt_pk_bf16_f32 v156, v40, v41
    v_exp_f32 v43, v123
    v_add_f32 v51, v51, v42
    v_exp_f32 v44, v124
    v_add_f32 v51, v51, v43
    v_cvt_pk_bf16_f32 v157, v42, v43
    v_exp_f32 v45, v125
    v_add_f32 v51, v51, v44
    v_exp_f32 v46, v126
    v_add_f32 v51, v51, v45
    v_cvt_pk_bf16_f32 v158, v44, v45
    v_exp_f32 v47, v127
    v_add_f32 v51, v51, v46
    s_nop 0
    v_add_f32 v51, v51, v47
    v_cvt_pk_bf16_f32 v159, v46, v47
    v_max_f32 v54, v50, v51
    v_cmp_lt_f32 vcc, s32, v54
    s_cbranch_vccnz F_stub11
F_back11:
    s_waitcnt vmcnt(20)
    s_barrier
    ds_read_b128 a[192:195], v24 offset:32768
    s_waitcnt lgkmcnt(3)
    v_mfma_f32_32x32x16_bf16 a[0:15], a[224:227], v[144:147], a[0:15]
    ds_read_b64_tr_b16 a[232:233], v38 offset:8192
    ds_read_b64_tr_b16 a[234:235], v38 offset:10240
    v_add_f32 v52, v52, v50
    v_add_f32 v53, v53, v51
    v_mfma_f32_32x32x16_bf16 a[16:31], a[224:227], v[152:155], a[16:31]
    v_exp_f32 v40, v64
    v_exp_f32 v41, v65
    s_waitcnt lgkmcnt(3)
    v_mfma_f32_32x32x16_bf16 a[32:47], a[228:231], v[144:147], a[32:47]
    ds_read_b128 a[196:199], v25 offset:32768
    v_exp_f32 v42, v66
    v_add_f32 v48, v40, v41
    v_cvt_pk_bf16_f32 v128, v40, v41
    v_mfma_f32_32x32x16_bf16 a[48:63], a[228:231], v[152:155], a[48:63]
    s_cmp_eq_u32 s24, s27
    s_cbranch_scc1 F_pt_skip1
    s_sub_u32 s35, s27, s24
    s_and_b32 s35, s35, 3
    s_cmp_lt_u32 s35, 3
    s_cbranch_scc1 F_pt_skip1
    s_lshl_b32 s35, s28, 2
    s_add_u32 s35, s35, s24
    s_lshl_b32 s35, s35, 2
    s_add_u32 s35, s35, s27
    s_mul_i32 s35, s35, 0x4400
    s_add_u32 s35, s35, 0x801000
    v_and_b32 v60, 31, v2
    v_lshlrev_b32 v60, 7, v60
    buffer_load_dword v61, v60, s[20:23], s35 offen
F_pt_skip1:
    s_waitcnt lgkmcnt(3)
    v_mfma_f32_32x32x16_bf16 v[96:111], a[192:195], a[128:131], v[160:175]
    ds_read_b64_tr_b16 a[236:237], v39 offset:8192
    ds_read_b64_tr_b16 a[238:239], v39 offset:10240
    v_exp_f32 v43, v67
    v_add_f32 v48, v48, v42
    v_mfma_f32_32x32x16_bf16 v[112:127], a[192:195], a[132:135], v[176:191]
    v_exp_f32 v44, v68
    v_add_f32 v48, v48, v43
    v_cvt_pk_bf16_f32 v129, v42, v43
    s_waitcnt lgkmcnt(3)
    v_mfma_f32_32x32x16_bf16 a[64:79], a[232:235], v[144:147], a[64:79]
    ds_read_b128 a[200:203], v26 offset:32768
    v_exp_f32 v45, v69
    v_add_f32 v48, v48, v44
    v_mfma_f32_32x32x16_bf16 a[80:95], a[232:235], v[152:155], a[80:95]
    s_add_u32 s34, s26, 4
    s_and_b32 s34, s34, 7
    s_lshl_b32 s34, s34, 16
    s_add_u32 s34, s34, s52
    s_add_u32 m0, s53, 49152
    s_add_u32 s33, s34, 0
    buffer_load_dwordx4 v205, s[48:51], s33 offen lds
    s_waitcnt lgkmcnt(3)
    v_mfma_f32_32x32x16_bf16 v[96:111], a[196:199], a[136:139], v[96:111]
    ds_read_b64_tr_b16 a[240:241], v36 offset:12288
    ds_read_b64_tr_b16 a[242:243], v36 offset:14336
    v_exp_f32 v46, v70
    v_add_f32 v48, v48, v45
    v_mfma_f32_32x32x16_bf16 v[112:127], a[196:199], a[140:143], v[112:127]
    v_cvt_pk_bf16_f32 v130, v44, v45
    v_exp_f32 v47, v71
    v_add_f32 v48, v48, v46
    s_waitcnt lgkmcnt(3)
    v_mfma_f32_32x32x16_bf16 a[96:111], a[236:239], v[144:147], a[96:111]
    ds_read_b128 a[204:207], v27 offset:32768
    v_exp_f32 v40, v72
    v_add_f32 v48, v48, v47
    v_cvt_pk_bf16_f32 v131, v46, v47
    v_mfma_f32_32x32x16_bf16 a[112:127], a[236:239], v[152:155], a[112:127]
    s_add_u32 m0, s53, 50176
    s_add_u32 s33, s34, 4096
    buffer_load_dwordx4 v205, s[48:51], s33 offen lds
    s_waitcnt lgkmcnt(3)
    v_mfma_f32_32x32x16_bf16 v[96:111], a[200:203], a[144:147], v[96:111]
    ds_read_b64_tr_b16 a[244:245], v37 offset:12288
    ds_read_b64_tr_b16 a[246:247], v37 offset:14336
    v_exp_f32 v41, v73
    v_add_f32 v48, v48, v40
    v_mfma_f32_32x32x16_bf16 v[112:127], a[200:203], a[148:151], v[112:127]
    v_exp_f32 v42, v74
    v_add_f32 v48, v48, v41
    v_cvt_pk_bf16_f32 v132, v40, v41
    s_waitcnt lgkmcnt(3)
    v_mfma_f32_32x32x16_bf16 a[0:15], a[240:243], v[148:151], a[0:15]
    ds_read_b128 a[208:211], v28 offset:32768
    v_exp_f32 v43, v75
    v_add_f32 v48, v48, v42
    v_mfma_f32_32x32x16_bf16 a[16:31], a[240:243], v[156:159], a[16:31]
    s_add_u32 m0, s53, 51200
    s_add_u32 s33, s34, 8192
    buffer_load_dwordx4 v205, s[48:51], s33 offen lds
    s_waitcnt lgkmcnt(3)
    v_mfma_f32_32x32x16_bf16 v[96:111], a[204:207], a[152:155], v[96:111]
    ds_read_b64_tr_b16 a[248:249], v38 offset:12288
    ds_read_b64_tr_b16 a[250:251], v38 offset:14336
    v_exp_f32 v44, v76
    v_add_f32 v48, v48, v43
    v_mfma_f32_32x32x16_bf16 v[112:127], a[204:207], a[156:159], v[112:127]
    v_cvt_pk_bf16_f32 v133, v42, v43
    v_exp_f32 v45, v77
    v_add_f32 v48, v48, v44
    s_waitcnt lgkmcnt(3)
    v_mfma_f32_32x32x16_bf16 a[32:47], a[244:247], v[148:151], a[32:47]
    ds_read_b128 a[212:215], v29 offset:32768
    v_exp_f32 v46, v78
    v_add_f32 v48, v48, v45
    v_cvt_pk_bf16_f32 v134, v44, v45
    v_mfma_f32_32x32x16_bf16 a[48:63], a[244:247], v[156:159], a[48:63]
    s_add_u32 m0, s53, 52224
    s_add_u32 s33, s34, 12288
    buffer_load_dwordx4 v205, s[48:51], s33 offen lds
    s_waitcnt lgkmcnt(3)
    v_mfma_f32_32x32x16_bf16 v[96:111], a[208:211], a[160:163], v[96:111]
    ds_read_b128 a[216:219], v30 offset:32768
    v_exp_f32 v47, v79
    v_add_f32 v48, v48, v46
    v_mfma_f32_32x32x16_bf16 v[112:127], a[208:211], a[164:167], v[112:127]
    v_exp_f32 v40, v80
    v_add_f32 v48, v48, v47
    v_cvt_pk_bf16_f32 v135, v46, v47
    s_waitcnt lgkmcnt(2)
    v_mfma_f32_32x32x16_bf16 a[64:79], a[248:251], v[148:151], a[64:79]
    ds_read_b128 a[220:223], v31 offset:32768
    v_exp_f32 v41, v81
    v_exp_f32 v42, v82
    v_mfma_f32_32x32x16_bf16 a[80:95], a[248:251], v[156:159], a[80:95]
    v_lshlrev_b32 v60, 6, v2
    buffer_load_dword v1, v60, s[20:23], s67 offen
    v_add_f32 v49, v40, v41
    v_cvt_pk_bf16_f32 v136, v40, v41
    s_waitcnt lgkmcnt(2)
    v_mfma_f32_32x32x16_bf16 v[96:111], a[212:215], a[168:171], v[96:111]
    ds_read_b64_tr_b16 a[252:253], v39 offset:12288
    ds_read_b64_tr_b16 a[254:255], v39 offset:14336
    v_exp_f32 v43, v83
    v_add_f32 v49, v49, v42
    v_mfma_f32_32x32x16_bf16 v[112:127], a[212:215], a[172:175], v[112:127]
    v_exp_f32 v44, v84
    v_add_f32 v49, v49, v43
    v_cvt_pk_bf16_f32 v137, v42, v43
    s_waitcnt lgkmcnt(3)
    v_mfma_f32_32x32x16_bf16 v[96:111], a[216:219], a[176:179], v[96:111]
    ds_read_b64_tr_b16 a[224:225], v36 offset:24576
    ds_read_b64_tr_b16 a[226:227], v36 offset:26624
    v_exp_f32 v45, v85
    v_add_f32 v49, v49, v44
    v_mfma_f32_32x32x16_bf16 v[112:127], a[216:219], a[180:183], v[112:127]
    v_exp_f32 v46, v86
    v_add_f32 v49, v49, v45
    v_cvt_pk_bf16_f32 v138, v44, v45
    s_waitcnt lgkmcnt(4)
    v_mfma_f32_32x32x16_bf16 v[96:111], a[220:223], a[184:187], v[96:111]
    ds_read_b64_tr_b16 a[228:229], v37 offset:24576
    ds_read_b64_tr_b16 a[230:231], v37 offset:26624
    v_exp_f32 v47, v87
    v_add_f32 v49, v49, v46
    v_mfma_f32_32x32x16_bf16 v[112:127], a[220:223], a[188:191], v[112:127]
    v_exp_f32 v40, v88
    v_add_f32 v49, v49, v47
    v_cvt_pk_bf16_f32 v139, v46, v47
    s_waitcnt lgkmcnt(4)
    v_mfma_f32_32x32x16_bf16 a[96:111], a[252:255], v[148:151], a[96:111]
    v_exp_f32 v41, v89
    v_add_f32 v49, v49, v40
    v_exp_f32 v42, v90
    v_mfma_f32_32x32x16_bf16 a[112:127], a[252:255], v[156:159], a[112:127]
    v_add_f32 v49, v49, v41
    v_cvt_pk_bf16_f32 v140, v40, v41
    v_exp_f32 v43, v91
    v_add_f32 v49, v49, v42
    v_exp_f32 v44, v92
    v_add_f32 v49, v49, v43
    v_cvt_pk_bf16_f32 v141, v42, v43
    v_exp_f32 v45, v93
    v_add_f32 v49, v49, v44
    v_exp_f32 v46, v94
    v_add_f32 v49, v49, v45
    v_cvt_pk_bf16_f32 v142, v44, v45
    v_exp_f32 v47, v95
    v_add_f32 v49, v49, v46
    s_nop 0
    v_add_f32 v49, v49, v47
    v_cvt_pk_bf16_f32 v143, v46, v47
    v_max_f32 v54, v48, v49
    v_cmp_lt_f32 vcc, s32, v54
    s_cbranch_vccnz F_stub12
F_back12:
    s_waitcnt vmcnt(17)
    s_barrier
    ds_read_b128 a[192:195], v24 offset:49152
    s_waitcnt lgkmcnt(3)
    v_mfma_f32_32x32x16_bf16 a[0:15], a[224:227], v[128:131], a[0:15]
    ds_read_b64_tr_b16 a[232:233], v38 offset:24576
    ds_read_b64_tr_b16 a[234:235], v38 offset:26624
    v_add_f32 v52, v52, v48
    v_add_f32 v53, v53, v49
    v_mfma_f32_32x32x16_bf16 a[16:31], a[224:227], v[136:139], a[16:31]
    v_exp_f32 v40, v96
    v_exp_f32 v41, v97
    s_waitcnt lgkmcnt(3)
    v_mfma_f32_32x32x16_bf16 a[32:47], a[228:231], v[128:131], a[32:47]
    ds_read_b128 a[196:199], v25 offset:49152
    v_exp_f32 v42, v98
    v_add_f32 v50, v40, v41
    v_cvt_pk_bf16_f32 v144, v40, v41
    v_mfma_f32_32x32x16_bf16 a[48:63], a[228:231], v[136:139], a[48:63]
    s_cmp_eq_u32 s24, s27
    s_cbranch_scc1 F_pt_skip2
    s_sub_u32 s35, s27, s24
    s_and_b32 s35, s35, 3
    s_cmp_lt_u32 s35, 3
    s_cbranch_scc1 F_pt_skip2
    s_lshl_b32 s35, s28, 2
    s_add_u32 s35, s35, s24
    s_lshl_b32 s35, s35, 2
    s_add_u32 s35, s35, s27
    s_mul_i32 s35, s35, 0x4400
    s_add_u32 s35, s35, 0x802000
    v_and_b32 v60, 31, v2
    v_lshlrev_b32 v60, 7, v60
    buffer_load_dword v61, v60, s[20:23], s35 offen
F_pt_skip2:
    s_waitcnt lgkmcnt(3)
    v_mfma_f32_32x32x16_bf16 v[64:79], a[192:195], a[128:131], v[160:175]
    ds_read_b64_tr_b16 a[236:237], v39 offset:24576
    ds_read_b64_tr_b16 a[238:239], v39 offset:26624
    v_exp_f32 v43, v99
    v_add_f32 v50, v50, v42
    v_mfma_f32_32x32x16_bf16 v[80:95], a[192:195], a[132:135], v[176:191]
    v_exp_f32 v44, v100
    v_add_f32 v50, v50, v43
    v_cvt_pk_bf16_f32 v145, v42, v43
    s_waitcnt lgkmcnt(3)
    v_mfma_f32_32x32x16_bf16 a[64:79], a[232:235], v[128:131], a[64:79]
    ds_read_b128 a[200:203], v26 offset:49152
    v_exp_f32 v45, v101
    v_add_f32 v50, v50, v44
    v_mfma_f32_32x32x16_bf16 a[80:95], a[232:235], v[136:139], a[80:95]
    v_lshlrev_b32 v60, 6, v2
    buffer_load_dword v1, v60, s[20:23], s66 offen
    v_exp_f32 v46, v102
    s_waitcnt lgkmcnt(3)
    v_mfma_f32_32x32x16_bf16 v[64:79], a[196:199], a[136:139], v[64:79]
    ds_read_b64_tr_b16 a[240:241], v36 offset:28672
    ds_read_b64_tr_b16 a[242:243], v36 offset:30720
    v_add_f32 v50, v50, v45
    v_cvt_pk_bf16_f32 v146, v44, v45
    v_mfma_f32_32x32x16_bf16 v[80:95], a[196:199], a[140:143], v[80:95]
    v_exp_f32 v47, v103
    v_add_f32 v50, v50, v46
    s_waitcnt lgkmcnt(3)
    v_mfma_f32_32x32x16_bf16 a[96:111], a[236:239], v[128:131], a[96:111]
    ds_read_b128 a[204:207], v27 offset:49152
    v_exp_f32 v40, v104
    v_add_f32 v50, v50, v47
    v_cvt_pk_bf16_f32 v147, v46, v47
    v_mfma_f32_32x32x16_bf16 a[112:127], a[236:239], v[136:139], a[112:127]
    s_add_u32 s34, s26, 5
    s_and_b32 s34, s34, 7
    s_lshl_b32 s34, s34, 16
    s_add_u32 s34, s34, s52
    s_add_u32 m0, s53, 65536
    s_add_u32 s33, s34, 0
    buffer_load_dwordx4 v205, s[48:51], s33 offen lds
    s_waitcnt lgkmcnt(3)
    v_mfma_f32_32x32x16_bf16 v[64:79], a[200:203], a[144:147], v[64:79]
    ds_read_b64_tr_b16 a[244:245], v37 offset:28672
    ds_read_b64_tr_b16 a[246:247], v37 offset:30720
    v_exp_f32 v41, v105
    v_add_f32 v50, v50, v40
    v_mfma_f32_32x32x16_bf16 v[80:95], a[200:203], a[148:151], v[80:95]
    v_exp_f32 v42, v106
    v_add_f32 v50, v50, v41
    v_cvt_pk_bf16_f32 v148, v40, v41
    s_waitcnt lgkmcnt(3)
    v_mfma_f32_32x32x16_bf16 a[0:15], a[240:243], v[132:135], a[0:15]
    ds_read_b128 a[208:211], v28 offset:49152
    v_exp_f32 v43, v107
    v_add_f32 v50, v50, v42
    v_mfma_f32_32x32x16_bf16 a[16:31], a[240:243], v[140:143], a[16:31]
    s_add_u32 m0, s53, 66560
    s_add_u32 s33, s34, 4096
    buffer_load_dwordx4 v205, s[48:51], s33 offen lds
    s_waitcnt lgkmcnt(3)
    v_mfma_f32_32x32x16_bf16 v[64:79], a[204:207], a[152:155], v[64:79]
    ds_read_b64_tr_b16 a[248:249], v38 offset:28672
    ds_read_b64_tr_b16 a[250:251], v38 offset:30720
    v_exp_f32 v44, v108
    v_add_f32 v50, v50, v43
    v_mfma_f32_32x32x16_bf16 v[80:95], a[204:207], a[156:159], v[80:95]
    v_cvt_pk_bf16_f32 v149, v42, v43
    v_exp_f32 v45, v109
    v_add_f32 v50, v50, v44
    s_waitcnt lgkmcnt(3)
    v_mfma_f32_32x32x16_bf16 a[32:47], a[244:247], v[132:135], a[32:47]
    ds_read_b128 a[212:215], v29 offset:49152
    v_exp_f32 v46, v110
    v_add_f32 v50, v50, v45
    v_cvt_pk_bf16_f32 v150, v44, v45
    v_mfma_f32_32x32x16_bf16 a[48:63], a[244:247], v[140:143], a[48:63]
    s_add_u32 m0, s53, 67584
    s_add_u32 s33, s34, 8192
    buffer_load_dwordx4 v205, s[48:51], s33 offen lds
    s_waitcnt lgkmcnt(3)
    v_mfma_f32_32x32x16_bf16 v[64:79], a[208:211], a[160:163], v[64:79]
    ds_read_b128 a[216:219], v30 offset:49152
    v_exp_f32 v47, v111
    v_add_f32 v50, v50, v46
    v_mfma_f32_32x32x16_bf16 v[80:95], a[208:211], a[164:167], v[80:95]
    v_exp_f32 v40, v112
    v_add_f32 v50, v50, v47
    v_cvt_pk_bf16_f32 v151, v46, v47
    s_waitcnt lgkmcnt(2)
    v_mfma_f32_32x32x16_bf16 a[64:79], a[248:251], v[132:135], a[64:79]
    ds_read_b128 a[220:223], v31 offset:49152
    v_exp_f32 v41, v113
    v_exp_f32 v42, v114
    v_mfma_f32_32x32x16_bf16 a[80:95], a[248:251], v[140:143], a[80:95]
    s_add_u32 m0, s53, 68608
    s_add_u32 s33, s34, 12288
    buffer_load_dwordx4 v205, s[48:51], s33 offen lds
    v_add_f32 v51, v40, v41
    s_waitcnt lgkmcnt(2)
    v_mfma_f32_32x32x16_bf16 v[64:79], a[212:215], a[168:171], v[64:79]
    ds_read_b64_tr_b16 a[252:253], v39 offset:28672
    ds_read_b64_tr_b16 a[254:255], v39 offset:30720
    v_cvt_pk_bf16_f32 v152, v40, v41
    v_exp_f32 v43, v115
    v_mfma_f32_32x32x16_bf16 v[80:95], a[212:215], a[172:175], v[80:95]
    v_add_f32 v51, v51, v42
    v_exp_f32 v44, v116
    v_add_f32 v51, v51, v43
    s_waitcnt lgkmcnt(3)
    v_mfma_f32_32x32x16_bf16 v[64:79], a[216:219], a[176:179], v[64:79]
    ds_read_b64_tr_b16 a[224:225], v36 offset:40960
    ds_read_b64_tr_b16 a[226:227], v36 offset:43008
    v_cvt_pk_bf16_f32 v153, v42, v43
    v_exp_f32 v45, v117
    v_mfma_f32_32x32x16_bf16 v[80:95], a[216:219], a[180:183], v[80:95]
    v_add_f32 v51, v51, v44
    v_exp_f32 v46, v118
    v_add_f32 v51, v51, v45
    s_waitcnt lgkmcnt(4)
    v_mfma_f32_32x32x16_bf16 v[64:79], a[220:223], a[184:187], v[64:79]
    ds_read_b64_tr_b16 a[228:229], v37 offset:40960
    ds_read_b64_tr_b16 a[230:231], v37 offset:43008
    v_cvt_pk_bf16_f32 v154, v44, v45
    v_exp_f32 v47, v119
    v_mfma_f32_32x32x16_bf16 v[80:95], a[220:223], a[188:191], v[80:95]
    v_add_f32 v51, v51, v46
    v_exp_f32 v40, v120
    v_add_f32 v51, v51, v47
    s_waitcnt lgkmcnt(4)
    v_mfma_f32_32x32x16_bf16 a[96:111], a[252:255], v[132:135], a[96:111]
    v_cvt_pk_bf16_f32 v155, v46, v47
    v_exp_f32 v41, v121
    v_add_f32 v51, v51, v40
    v_mfma_f32_32x32x16_bf16 a[112:127], a[252:255], v[140:143], a[112:127]
    v_exp_f32 v42, v122
    v_add_f32 v51, v51, v41
    v_cvt_pk_bf16_f32 v156, v40, v41
    v_exp_f32 v43, v123
    v_add_f32 v51, v51, v42
    v_exp_f32 v44, v124
    v_add_f32 v51, v51, v43
    v_cvt_pk_bf16_f32 v157, v42, v43
    v_exp_f32 v45, v125
    v_add_f32 v51, v51, v44
    v_exp_f32 v46, v126
    v_add_f32 v51, v51, v45
    v_cvt_pk_bf16_f32 v158, v44, v45
    v_exp_f32 v47, v127
    v_add_f32 v51, v51, v46
    s_nop 0
    v_add_f32 v51, v51, v47
    v_cvt_pk_bf16_f32 v159, v46, v47
    v_max_f32 v54, v50, v51
    v_cmp_lt_f32 vcc, s32, v54
    s_cbranch_vccnz F_stub13
F_back13:
    s_waitcnt vmcnt(14)
    s_barrier
    ds_read_b128 a[192:195], v192 offset:0
    s_waitcnt lgkmcnt(3)
    v_mfma_f32_32x32x16_bf16 a[0:15], a[224:227], v[144:147], a[0:15]
    ds_read_b64_tr_b16 a[232:233], v38 offset:40960
    ds_read_b64_tr_b16 a[234:235], v38 offset:43008
    v_add_f32 v52, v52, v50
    v_add_f32 v53, v53, v51
    v_mfma_f32_32x32x16_bf16 a[16:31], a[224:227], v[152:155], a[16:31]
    v_exp_f32 v40, v64
    v_exp_f32 v41, v65
    s_waitcnt lgkmcnt(3)
    v_mfma_f32_32x32x16_bf16 a[32:47], a[228:231], v[144:147], a[32:47]
    ds_read_b128 a[196:199], v193 offset:0
    v_exp_f32 v42, v66
    v_add_f32 v48, v40, v41
    v_cvt_pk_bf16_f32 v128, v40, v41
    v_mfma_f32_32x32x16_bf16 a[48:63], a[228:231], v[152:155], a[48:63]
    s_cmp_eq_u32 s24, s27
    s_cbranch_scc1 F_pt_skip3
    s_sub_u32 s35, s27, s24
    s_and_b32 s35, s35, 3
    s_cmp_lt_u32 s35, 3
    s_cbranch_scc1 F_pt_skip3
    s_lshl_b32 s35, s28, 2
    s_add_u32 s35, s35, s24
    s_lshl_b32 s35, s35, 2
    s_add_u32 s35, s35, s27
    s_mul_i32 s35, s35, 0x4400
    s_add_u32 s35, s35, 0x803000
    v_and_b32 v60, 31, v2
    v_lshlrev_b32 v60, 7, v60
    buffer_load_dword v61, v60, s[20:23], s35 offen
F_pt_skip3:
    s_waitcnt lgkmcnt(3)
    v_mfma_f32_32x32x16_bf16 v[96:111], a[192:195], a[128:131], v[160:175]
    ds_read_b64_tr_b16 a[236:237], v39 offset:40960
    ds_read_b64_tr_b16 a[238:239], v39 offset:43008
    v_exp_f32 v43, v67
    v_add_f32 v48, v48, v42
    v_mfma_f32_32x32x16_bf16 v[112:127], a[192:195], a[132:135], v[176:191]
    v_exp_f32 v44, v68
    v_add_f32 v48, v48, v43
    v_cvt_pk_bf16_f32 v129, v42, v43
    s_waitcnt lgkmcnt(3)
    v_mfma_f32_32x32x16_bf16 a[64:79], a[232:235], v[144:147], a[64:79]
    ds_read_b128 a[200:203], v194 offset:0
    v_exp_f32 v45, v69
    v_add_f32 v48, v48, v44
    v_mfma_f32_32x32x16_bf16 a[80:95], a[232:235], v[152:155], a[80:95]
    s_add_u32 s34, s26, 6
    s_and_b32 s34, s34, 7
    s_lshl_b32 s34, s34, 16
    s_add_u32 s34, s34, s52
    s_add_u32 m0, s53, 81920
    s_add_u32 s33, s34, 0
    buffer_load_dwordx4 v205, s[48:51], s33 offen lds
    s_waitcnt lgkmcnt(3)
    v_mfma_f32_32x32x16_bf16 v[96:111], a[196:199], a[136:139], v[96:111]
    ds_read_b64_tr_b16 a[240:241], v36 offset:45056
    ds_read_b64_tr_b16 a[242:243], v36 offset:47104
    v_exp_f32 v46, v70
    v_add_f32 v48, v48, v45
    v_mfma_f32_32x32x16_bf16 v[112:127], a[196:199], a[140:143], v[112:127]
    v_cvt_pk_bf16_f32 v130, v44, v45
    v_exp_f32 v47, v71
    v_add_f32 v48, v48, v46
    s_waitcnt lgkmcnt(3)
    v_mfma_f32_32x32x16_bf16 a[96:111], a[236:239], v[144:147], a[96:111]
    ds_read_b128 a[204:207], v195 offset:0
    v_exp_f32 v40, v72
    v_add_f32 v48, v48, v47
    v_cvt_pk_bf16_f32 v131, v46, v47
    v_mfma_f32_32x32x16_bf16 a[112:127], a[236:239], v[152:155], a[112:127]
    s_add_u32 m0, s53, 82944
    s_add_u32 s33, s34, 4096
    buffer_load_dwordx4 v205, s[48:51], s33 offen lds
    s_waitcnt lgkmcnt(3)
    v_mfma_f32_32x32x16_bf16 v[96:111], a[200:203], a[144:147], v[96:111]
    ds_read_b64_tr_b16 a[244:245], v37 offset:45056
    ds_read_b64_tr_b16 a[246:247], v37 offset:47104
    v_exp_f32 v41, v73
    v_add_f32 v48, v48, v40
    v_mfma_f32_32x32x16_bf16 v[112:127], a[200:203], a[148:151], v[112:127]
    v_exp_f32 v42, v74
    v_add_f32 v48, v48, v41
    v_cvt_pk_bf16_f32 v132, v40, v41
    s_waitcnt lgkmcnt(3)
    v_mfma_f32_32x32x16_bf16 a[0:15], a[240:243], v[148:151], a[0:15]
    ds_read_b128 a[208:211], v196 offset:0
    v_exp_f32 v43, v75
    v_add_f32 v48, v48, v42
    v_mfma_f32_32x32x16_bf16 a[16:31], a[240:243], v[156:159], a[16:31]
    s_add_u32 m0, s53, 83968
    s_add_u32 s33, s34, 8192
    buffer_load_dwordx4 v205, s[48:51], s33 offen lds
    s_waitcnt lgkmcnt(3)
    v_mfma_f32_32x32x16_bf16 v[96:111], a[204:207], a[152:155], v[96:111]
    ds_read_b64_tr_b16 a[248:249], v38 offset:45056
    ds_read_b64_tr_b16 a[250:251], v38 offset:47104
    v_exp_f32 v44, v76
    v_add_f32 v48, v48, v43
    v_mfma_f32_32x32x16_bf16 v[112:127], a[204:207], a[156:159], v[112:127]
    v_cvt_pk_bf16_f32 v133, v42, v43
    v_exp_f32 v45, v77
    v_add_f32 v48, v48, v44
    s_waitcnt lgkmcnt(3)
    v_mfma_f32_32x32x16_bf16 a[32:47], a[244:247], v[148:151], a[32:47]
    ds_read_b128 a[212:215], v197 offset:0
    v_exp_f32 v46, v78
    v_add_f32 v48, v48, v45
    v_cvt_pk_bf16_f32 v134, v44, v45
    v_mfma_f32_32x32x16_bf16 a[48:63], a[244:247], v[156:159], a[48:63]
    s_add_u32 m0, s53, 84992
    s_add_u32 s33, s34, 12288
    buffer_load_dwordx4 v205, s[48:51], s33 offen lds
    s_waitcnt lgkmcnt(3)
    v_mfma_f32_32x32x16_bf16 v[96:111], a[208:211], a[160:163], v[96:111]
    ds_read_b128 a[216:219], v198 offset:0
    v_exp_f32 v47, v79
    v_add_f32 v48, v48, v46
    v_mfma_f32_32x32x16_bf16 v[112:127], a[208:211], a[164:167], v[112:127]
    v_exp_f32 v40, v80
    v_add_f32 v48, v48, v47
    v_cvt_pk_bf16_f32 v135, v46, v47
    s_waitcnt lgkmcnt(2)
    v_mfma_f32_32x32x16_bf16 a[64:79], a[248:251], v[148:151], a[64:79]
    ds_read_b128 a[220:223], v199 offset:0
    v_exp_f32 v41, v81
    v_exp_f32 v42, v82
    v_mfma_f32_32x32x16_bf16 a[80:95], a[248:251], v[156:159], a[80:95]
    v_add_f32 v49, v40, v41
    v_cvt_pk_bf16_f32 v136, v40, v41
    v_exp_f32 v43, v83
    s_waitcnt lgkmcnt(2)
    v_mfma_f32_32x32x16_bf16 v[96:111], a[212:215], a[168:171], v[96:111]
    ds_read_b64_tr_b16 a[252:253], v39 offset:45056
    ds_read_b64_tr_b16 a[254:255], v39 offset:47104
    v_add_f32 v49, v49, v42
    v_exp_f32 v44, v84
    v_mfma_f32_32x32x16_bf16 v[112:127], a[212:215], a[172:175], v[112:127]
    v_add_f32 v49, v49, v43
    v_cvt_pk_bf16_f32 v137, v42, v43
    v_exp_f32 v45, v85
    s_waitcnt lgkmcnt(3)
    v_mfma_f32_32x32x16_bf16 v[96:111], a[216:219], a[176:179], v[96:111]
    ds_read_b64_tr_b16 a[224:225], v36 offset:57344
    ds_read_b64_tr_b16 a[226:227], v36 offset:59392
    v_add_f32 v49, v49, v44
    v_exp_f32 v46, v86
    v_mfma_f32_32x32x16_bf16 v[112:127], a[216:219], a[180:183], v[112:127]
    v_add_f32 v49, v49, v45
    v_cvt_pk_bf16_f32 v138, v44, v45
    v_exp_f32 v47, v87
    s_waitcnt lgkmcnt(4)
    v_mfma_f32_32x32x16_bf16 v[96:111], a[220:223], a[184:187], v[96:111]
    ds_read_b64_tr_b16 a[228:229], v37 offset:57344
    ds_read_b64_tr_b16 a[230:231], v37 offset:59392
    v_add_f32 v49, v49, v46
    v_exp_f32 v40, v88
    v_mfma_f32_32x32x16_bf16 v[112:127], a[220:223], a[188:191], v[112:127]
    v_add_f32 v49, v49, v47
    v_cvt_pk_bf16_f32 v139, v46, v47
    v_exp_f32 v41, v89
    s_waitcnt lgkmcnt(4)
    v_mfma_f32_32x32x16_bf16 a[96:111], a[252:255], v[148:151], a[96:111]
    ds_read_b64_tr_b16 a[232:233], v38 offset:57344
    ds_read_b64_tr_b16 a[234:235], v38 offset:59392
    v_add_f32 v49, v49, v40
    v_exp_f32 v42, v90
    v_mfma_f32_32x32x16_bf16 a[112:127], a[252:255], v[156:159], a[112:127]
    v_add_f32 v49, v49, v41
    v_cvt_pk_bf16_f32 v140, v40, v41
    v_exp_f32 v43, v91
    v_add_f32 v49, v49, v42
    v_exp_f32 v44, v92
    v_add_f32 v49, v49, v43
    v_cvt_pk_bf16_f32 v141, v42, v43
    v_exp_f32 v45, v93
    v_add_f32 v49, v49, v44
    v_exp_f32 v46, v94
    v_add_f32 v49, v49, v45
    v_cvt_pk_bf16_f32 v142, v44, v45
    v_exp_f32 v47, v95
    v_add_f32 v49, v49, v46
    s_nop 0
    v_add_f32 v49, v49, v47
    v_cvt_pk_bf16_f32 v143, v46, v47
    v_max_f32 v54, v48, v49
    v_cmp_lt_f32 vcc, s32, v54
    s_cbranch_vccnz F_stub14
F_back14:
    s_barrier
    s_waitcnt lgkmcnt(4)
    v_mfma_f32_32x32x16_bf16 a[0:15], a[224:227], v[128:131], a[0:15]
    ds_read_b64_tr_b16 a[236:237], v39 offset:57344
    ds_read_b64_tr_b16 a[238:239], v39 offset:59392
    v_add_f32 v52, v52, v48
    v_add_f32 v53, v53, v49
    v_mfma_f32_32x32x16_bf16 a[16:31], a[224:227], v[136:139], a[16:31]
    v_exp_f32 v40, v96
    v_exp_f32 v41, v97
    s_waitcnt lgkmcnt(4)
    v_mfma_f32_32x32x16_bf16 a[32:47], a[228:231], v[128:131], a[32:47]
    ds_read_b64_tr_b16 a[240:241], v36 offset:61440
    ds_read_b64_tr_b16 a[242:243], v36 offset:63488
    v_exp_f32 v42, v98
    v_add_f32 v50, v40, v41
    v_mfma_f32_32x32x16_bf16 a[48:63], a[228:231], v[136:139], a[48:63]
    s_cmp_eq_u32 s24, s27
    s_cbranch_scc1 F_pt_skip4
    s_lshl_b32 s35, s28, 2
    s_add_u32 s35, s35, s24
    s_lshl_b32 s35, s35, 2
    s_add_u32 s35, s35, s27
    s_mul_i32 s35, s35, 0x4400
    s_add_u32 s35, s35, 0x804000
    v_and_b32 v60, 7, v2
    v_lshlrev_b32 v60, 7, v60
    buffer_load_dword v61, v60, s[20:23], s35 offen
F_pt_skip4:
    s_waitcnt lgkmcnt(4)
    v_mfma_f32_32x32x16_bf16 a[64:79], a[232:235], v[128:131], a[64:79]
    ds_read_b64_tr_b16 a[244:245], v37 offset:61440
    ds_read_b64_tr_b16 a[246:247], v37 offset:63488
    v_cvt_pk_bf16_f32 v144, v40, v41
    v_exp_f32 v43, v99
    v_mfma_f32_32x32x16_bf16 a[80:95], a[232:235], v[136:139], a[80:95]
    s_add_u32 s34, s26, 7
    s_and_b32 s34, s34, 7
    s_lshl_b32 s34, s34, 16
    s_add_u32 s34, s34, s52
    s_add_u32 m0, s53, 98304
    s_add_u32 s33, s34, 0
    buffer_load_dwordx4 v205, s[48:51], s33 offen lds
    s_waitcnt lgkmcnt(4)
    v_mfma_f32_32x32x16_bf16 a[96:111], a[236:239], v[128:131], a[96:111]
    ds_read_b64_tr_b16 a[248:249], v38 offset:61440
    ds_read_b64_tr_b16 a[250:251], v38 offset:63488
    v_add_f32 v50, v50, v42
    v_exp_f32 v44, v100
    v_mfma_f32_32x32x16_bf16 a[112:127], a[236:239], v[136:139], a[112:127]
    s_add_u32 m0, s53, 99328
    s_add_u32 s33, s34, 4096
    buffer_load_dwordx4 v205, s[48:51], s33 offen lds
    v_add_f32 v50, v50, v43
    s_waitcnt lgkmcnt(4)
    v_mfma_f32_32x32x16_bf16 a[0:15], a[240:243], v[132:135], a[0:15]
    ds_read_b64_tr_b16 a[252:253], v39 offset:61440
    ds_read_b64_tr_b16 a[254:255], v39 offset:63488
    v_cvt_pk_bf16_f32 v145, v42, v43
    v_exp_f32 v45, v101
    v_mfma_f32_32x32x16_bf16 a[16:31], a[240:243], v[140:143], a[16:31]
    v_add_f32 v50, v50, v44
    v_exp_f32 v46, v102
    v_add_f32 v50, v50, v45
    s_waitcnt lgkmcnt(4)
    v_mfma_f32_32x32x16_bf16 a[32:47], a[244:247], v[132:135], a[32:47]
    ds_read_b64_tr_b16 a[224:225], v200 offset:8192
    ds_read_b64_tr_b16 a[226:227], v200 offset:10240
    v_cvt_pk_bf16_f32 v146, v44, v45
    v_exp_f32 v47, v103
    v_mfma_f32_32x32x16_bf16 a[48:63], a[244:247], v[140:143], a[48:63]
    s_add_u32 m0, s53, 100352
    s_add_u32 s33, s34, 8192
    buffer_load_dwordx4 v205, s[48:51], s33 offen lds
    v_add_f32 v50, v50, v46
    s_waitcnt lgkmcnt(4)
    v_mfma_f32_32x32x16_bf16 a[64:79], a[248:251], v[132:135], a[64:79]
    ds_read_b64_tr_b16 a[240:241], v200 offset:12288
    ds_read_b64_tr_b16 a[242:243], v200 offset:14336
    v_exp_f32 v40, v104
    v_add_f32 v50, v50, v47
    v_mfma_f32_32x32x16_bf16 a[80:95], a[248:251], v[140:143], a[80:95]
    v_cvt_pk_bf16_f32 v147, v46, v47
    v_exp_f32 v41, v105
    v_add_f32 v50, v50, v40
    s_waitcnt lgkmcnt(4)
    v_mfma_f32_32x32x16_bf16 a[96:111], a[252:255], v[132:135], a[96:111]
    ds_read_b64_tr_b16 a[228:229], v201 offset:8192
    ds_read_b64_tr_b16 a[230:231], v201 offset:10240
    v_exp_f32 v42, v106
    v_add_f32 v50, v50, v41
    v_mfma_f32_32x32x16_bf16 a[112:127], a[252:255], v[140:143], a[112:127]
    s_add_u32 m0, s53, 101376
    s_add_u32 s33, s34, 12288
    buffer_load_dwordx4 v205, s[48:51], s33 offen lds
    v_cvt_pk_bf16_f32 v148, v40, v41
    v_exp_f32 v43, v107
    v_add_f32 v50, v50, v42
    v_exp_f32 v44, v108
    v_add_f32 v50, v50, v43
    v_cvt_pk_bf16_f32 v149, v42, v43
    v_exp_f32 v45, v109
    v_add_f32 v50, v50, v44
    v_exp_f32 v46, v110
    v_add_f32 v50, v50, v45
    v_cvt_pk_bf16_f32 v150, v44, v45
    v_exp_f32 v47, v111
    v_add_f32 v50, v50, v46
    v_exp_f32 v40, v112
    v_add_f32 v50, v50, v47
    v_cvt_pk_bf16_f32 v151, v46, v47
    v_exp_f32 v41, v113
    v_exp_f32 v42, v114
    v_add_f32 v51, v40, v41
    v_cvt_pk_bf16_f32 v152, v40, v41
    v_exp_f32 v43, v115
    v_add_f32 v51, v51, v42
    v_exp_f32 v44, v116
    v_add_f32 v51, v51, v43
    v_cvt_pk_bf16_f32 v153, v42, v43
    v_exp_f32 v45, v117
    v_add_f32 v51, v51, v44
    v_exp_f32 v46, v118
    v_add_f32 v51, v51, v45
    v_cvt_pk_bf16_f32 v154, v44, v45
    v_exp_f32 v47, v119
    v_add_f32 v51, v51, v46
    v_exp_f32 v40, v120
    v_add_f32 v51, v51, v47
    v_cvt_pk_bf16_f32 v155, v46, v47
    v_exp_f32 v41, v121
    v_add_f32 v51, v51, v40
    v_exp_f32 v42, v122
    v_add_f32 v51, v51, v41
    v_cvt_pk_bf16_f32 v156, v40, v41
    v_exp_f32 v43, v123
    v_add_f32 v51, v51, v42
    v_exp_f32 v44, v124
    v_add_f32 v51, v51, v43
    v_cvt_pk_bf16_f32 v157, v42, v43
    v_exp_f32 v45, v125
    v_add_f32 v51, v51, v44
    v_exp_f32 v46, v126
    v_add_f32 v51, v51, v45
    v_cvt_pk_bf16_f32 v158, v44, v45
    v_exp_f32 v47, v127
    v_add_f32 v51, v51, v46
    s_nop 0
    v_add_f32 v51, v51, v47
    v_cvt_pk_bf16_f32 v159, v46, v47
    v_max_f32 v54, v50, v51
    v_cmp_lt_f32 vcc, s32, v54
    s_cbranch_vccnz F_stub15
F_back15:
    s_barrier
    s_waitcnt lgkmcnt(4)
    v_mfma_f32_32x32x16_bf16 a[0:15], a[224:227], v[144:147], a[0:15]
    ds_read_b64_tr_b16 a[244:245], v201 offset:12288
    ds_read_b64_tr_b16 a[246:247], v201 offset:14336
    v_add_f32 v52, v52, v50
    v_add_f32 v53, v53, v51
    v_mov_b32 v55, v52
    v_mfma_f32_32x32x16_bf16 a[16:31], a[224:227], v[152:155], a[16:31]
    s_nop 1
    v_permlane32_swap_b32 v52, v55
    s_nop 1
    v_add_f32 v57, v52, v55
    s_waitcnt lgkmcnt(4)
    v_mfma_f32_32x32x16_bf16 a[0:15], a[240:243], v[148:151], a[0:15]
    ds_read_b64_tr_b16 a[232:233], v202 offset:8192
    ds_read_b64_tr_b16 a[234:235], v202 offset:10240
    v_sub_f32 v56, 0, v160
    v_mov_b32 v55, v53
    s_nop 1
    v_mfma_f32_32x32x16_bf16 a[16:31], a[240:243], v[156:159], a[16:31]
    v_permlane32_swap_b32 v53, v55
    s_nop 1
    v_add_f32 v59, v53, v55
    v_sub_f32 v58, 0, v176
    s_waitcnt lgkmcnt(4)
    v_mfma_f32_32x32x16_bf16 a[32:47], a[228:231], v[144:147], a[32:47]
    ds_read_b64_tr_b16 a[248:249], v202 offset:12288
    ds_read_b64_tr_b16 a[250:251], v202 offset:14336
    v_mfma_f32_32x32x16_bf16 a[48:63], a[228:231], v[152:155], a[48:63]
    s_waitcnt lgkmcnt(4)
    v_mfma_f32_32x32x16_bf16 a[32:47], a[244:247], v[148:151], a[32:47]
    ds_read_b64_tr_b16 a[236:237], v203 offset:8192
    ds_read_b64_tr_b16 a[238:239], v203 offset:10240
    v_accvgpr_read_b32 v64, a0
    v_accvgpr_read_b32 v65, a1
    v_accvgpr_read_b32 v66, a2
    v_mfma_f32_32x32x16_bf16 a[48:63], a[244:247], v[156:159], a[48:63]
    v_accvgpr_read_b32 v67, a3
    v_accvgpr_read_b32 v68, a4
    v_accvgpr_read_b32 v69, a5
    v_accvgpr_read_b32 v70, a6
    s_waitcnt lgkmcnt(4)
    v_mfma_f32_32x32x16_bf16 a[64:79], a[232:235], v[144:147], a[64:79]
    ds_read_b64_tr_b16 a[252:253], v203 offset:12288
    ds_read_b64_tr_b16 a[254:255], v203 offset:14336
    v_accvgpr_read_b32 v71, a7
    v_cvt_pk_bf16_f32 v192, v64, v65
    v_cvt_pk_bf16_f32 v193, v66, v67
    v_mfma_f32_32x32x16_bf16 a[80:95], a[232:235], v[152:155], a[80:95]
    v_cvt_pk_bf16_f32 v194, v68, v69
    v_cvt_pk_bf16_f32 v195, v70, v71
    v_accvgpr_read_b32 v72, a8
    v_accvgpr_read_b32 v73, a9
    s_waitcnt lgkmcnt(4)
    v_mfma_f32_32x32x16_bf16 a[64:79], a[248:251], v[148:151], a[64:79]
    v_accvgpr_read_b32 v74, a10
    v_accvgpr_read_b32 v75, a11
    v_accvgpr_read_b32 v76, a12
    v_accvgpr_read_b32 v77, a13
    v_accvgpr_read_b32 v78, a14
    v_mfma_f32_32x32x16_bf16 a[80:95], a[248:251], v[156:159], a[80:95]
    v_accvgpr_read_b32 v79, a15
    v_cvt_pk_bf16_f32 v196, v72, v73
    v_cvt_pk_bf16_f32 v197, v74, v75
    v_cvt_pk_bf16_f32 v198, v76, v77
    s_waitcnt lgkmcnt(2)
    v_mfma_f32_32x32x16_bf16 a[96:111], a[236:239], v[144:147], a[96:111]
    v_cvt_pk_bf16_f32 v199, v78, v79
    v_accvgpr_read_b32 v80, a16
    v_accvgpr_read_b32 v81, a17
    v_accvgpr_read_b32 v82, a18
    v_accvgpr_read_b32 v83, a19
    v_mfma_f32_32x32x16_bf16 a[112:127], a[236:239], v[152:155], a[112:127]
    v_accvgpr_read_b32 v84, a20
    v_accvgpr_read_b32 v85, a21
    v_accvgpr_read_b32 v86, a22
    v_accvgpr_read_b32 v87, a23
    s_waitcnt lgkmcnt(0)
    v_mfma_f32_32x32x16_bf16 a[96:111], a[252:255], v[148:151], a[96:111]
    v_cvt_pk_bf16_f32 v200, v80, v81
    v_cvt_pk_bf16_f32 v201, v82, v83
    v_cvt_pk_bf16_f32 v202, v84, v85
    v_cvt_pk_bf16_f32 v203, v86, v87
    v_accvgpr_read_b32 v88, a24
    v_mfma_f32_32x32x16_bf16 a[112:127], a[252:255], v[156:159], a[112:127]
    v_accvgpr_read_b32 v89, a25
    v_accvgpr_read_b32 v90, a26
    v_accvgpr_read_b32 v91, a27
    v_accvgpr_read_b32 v92, a28
    v_accvgpr_read_b32 v93, a29
    v_accvgpr_read_b32 v94, a30
    v_accvgpr_read_b32 v95, a31
    v_cvt_pk_bf16_f32 v204, v88, v89
    v_cvt_pk_bf16_f32 v205, v90, v91
    v_cvt_pk_bf16_f32 v206, v92, v93
    v_cvt_pk_bf16_f32 v207, v94, v95
    v_accvgpr_read_b32 v64, a32
    v_accvgpr_read_b32 v65, a33
    v_accvgpr_read_b32 v66, a34
    v_accvgpr_read_b32 v67, a35
    v_accvgpr_read_b32 v68, a36
    v_accvgpr_read_b32 v69, a37
    v_accvgpr_read_b32 v70, a38
    v_accvgpr_read_b32 v71, a39
    v_cvt_pk_bf16_f32 v208, v64, v65
    v_cvt_pk_bf16_f32 v209, v66, v67
    v_cvt_pk_bf16_f32 v210, v68, v69
    v_cvt_pk_bf16_f32 v211, v70, v71
    v_accvgpr_read_b32 v72, a40
    v_accvgpr_read_b32 v73, a41
    v_accvgpr_read_b32 v74, a42
    v_accvgpr_read_b32 v75, a43
    v_accvgpr_read_b32 v76, a44
    v_accvgpr_read_b32 v77, a45
    v_accvgpr_read_b32 v78, a46
    v_accvgpr_read_b32 v79, a47
    v_cvt_pk_bf16_f32 v212, v72, v73
    v_cvt_pk_bf16_f32 v213, v74, v75
    v_cvt_pk_bf16_f32 v214, v76, v77
    v_cvt_pk_bf16_f32 v215, v78, v79
    v_accvgpr_read_b32 v80, a48
    v_accvgpr_read_b32 v81, a49
    v_accvgpr_read_b32 v82, a50
    v_accvgpr_read_b32 v83, a51
    v_accvgpr_read_b32 v84, a52
    v_accvgpr_read_b32 v85, a53
    v_accvgpr_read_b32 v86, a54
    v_accvgpr_read_b32 v87, a55
    v_cvt_pk_bf16_f32 v216, v80, v81
    v_cvt_pk_bf16_f32 v217, v82, v83
    v_cvt_pk_bf16_f32 v218, v84, v85
    v_cvt_pk_bf16_f32 v219, v86, v87
    v_accvgpr_read_b32 v88, a56
    v_accvgpr_read_b32 v89, a57
    v_accvgpr_read_b32 v90, a58
    v_accvgpr_read_b32 v91, a59
    v_accvgpr_read_b32 v92, a60
    v_accvgpr_read_b32 v93, a61
    v_accvgpr_read_b32 v94, a62
    v_accvgpr_read_b32 v95, a63
    v_cvt_pk_bf16_f32 v220, v88, v89
    v_cvt_pk_bf16_f32 v221, v90, v91
    v_cvt_pk_bf16_f32 v222, v92, v93
    v_cvt_pk_bf16_f32 v223, v94, v95
    v_accvgpr_read_b32 v64, a64
    v_accvgpr_read_b32 v65, a65
    v_accvgpr_read_b32 v66, a66
    v_accvgpr_read_b32 v67, a67
    v_accvgpr_read_b32 v68, a68
    v_accvgpr_read_b32 v69, a69
    v_accvgpr_read_b32 v70, a70
    v_accvgpr_read_b32 v71, a71
    v_cvt_pk_bf16_f32 v224, v64, v65
    v_cvt_pk_bf16_f32 v225, v66, v67
    v_cvt_pk_bf16_f32 v226, v68, v69
    v_cvt_pk_bf16_f32 v227, v70, v71
    v_accvgpr_read_b32 v72, a72
    v_accvgpr_read_b32 v73, a73
    v_accvgpr_read_b32 v74, a74
    v_accvgpr_read_b32 v75, a75
    v_accvgpr_read_b32 v76, a76
    v_accvgpr_read_b32 v77, a77
    v_accvgpr_read_b32 v78, a78
    v_accvgpr_read_b32 v79, a79
    v_cvt_pk_bf16_f32 v228, v72, v73
    v_cvt_pk_bf16_f32 v229, v74, v75
    v_cvt_pk_bf16_f32 v230, v76, v77
    v_cvt_pk_bf16_f32 v231, v78, v79
    v_accvgpr_read_b32 v80, a80
    v_accvgpr_read_b32 v81, a81
    v_accvgpr_read_b32 v82, a82
    v_accvgpr_read_b32 v83, a83
    v_accvgpr_read_b32 v84, a84
    v_accvgpr_read_b32 v85, a85
    v_accvgpr_read_b32 v86, a86
    v_accvgpr_read_b32 v87, a87
    v_cvt_pk_bf16_f32 v232, v80, v81
    v_cvt_pk_bf16_f32 v233, v82, v83
    v_cvt_pk_bf16_f32 v234, v84, v85
    v_cvt_pk_bf16_f32 v235, v86, v87
    v_accvgpr_read_b32 v88, a88
    v_accvgpr_read_b32 v89, a89
    v_accvgpr_read_b32 v90, a90
    v_accvgpr_read_b32 v91, a91
    v_accvgpr_read_b32 v92, a92
    v_accvgpr_read_b32 v93, a93
    v_accvgpr_read_b32 v94, a94
    v_accvgpr_read_b32 v95, a95
    v_cvt_pk_bf16_f32 v236, v88, v89
    v_cvt_pk_bf16_f32 v237, v90, v91
    v_cvt_pk_bf16_f32 v238, v92, v93
    v_cvt_pk_bf16_f32 v239, v94, v95
    s_cmp_lg_u32 s38, 0
    s_cbranch_scc1 F_tn_ok
    v_mov_b32 v7, 0
    s_mov_b32 s44, 0
F_tn_rd:
    global_load_dwordx2 v[8:9], v7, s[60:61] sc1
    s_waitcnt vmcnt(0)
    v_readfirstlane_b32 s38, v8
    v_readfirstlane_b32 s39, v9
    s_add_u32 s44, s44, 1
    s_cmp_lg_u32 s38, 0
    s_cbranch_scc1 F_tn_ok
    s_cmp_lt_u32 s44, 300000
    s_cbranch_scc1 F_tn_rd
F_tn_ok:
    s_waitcnt vmcnt(0)
    s_lshl_b32 s35, s28, 2
    s_add_u32 s35, s35, s24
    s_lshl_b32 s35, s35, 2
    s_add_u32 s35, s35, s27
    s_mul_i32 s35, s35, 0x4400
    s_add_u32 s35, s35, 0x800000
    v_lshlrev_b32 v14, 3, v2
    s_add_u32 s55, s35, 16384
    s_lshl_b32 s40, s26, 5
    s_lshl_b32 s41, s25, 2
    s_add_u32 s40, s40, s41
    s_add_u32 s40, s40, s24
    s_lshl_b32 s40, s40, 14
    s_add_u32 s40, s40, 0x400000
    s_sub_u32 s41, s27, s24
    s_and_b32 s41, s41, 3
    s_cmp_eq_u32 s41, 1
    s_cselect_b32 s35, s40, s35
    s_sub_u32 s40, s40, 0x400000
    s_cmp_eq_u32 s41, 2
    s_cselect_b32 s35, s40, s35
    v_add_u32 v15, 114688, v13
    v_add_u32 v60, 131072, v14
    s_cmp_eq_u32 s24, s27
    s_cbranch_scc0 F_pst_remote0
    ds_write_b128 v15, v[192:195] offset:0
    ds_write_b128 v15, v[196:199] offset:1024
    ds_write_b128 v15, v[200:203] offset:2048
    ds_write_b128 v15, v[204:207] offset:3072
    ds_write_b128 v15, v[208:211] offset:4096
    ds_write_b128 v15, v[212:215] offset:5120
    ds_write_b128 v15, v[216:219] offset:6144
    ds_write_b128 v15, v[220:223] offset:7168
    ds_write_b64 v60, v[56:57]
    ds_write_b64 v60, v[58:59] offset:512
    s_branch F_pst_done0
F_pst_remote0:
    s_cmp_lg_u32 s68, 0
    s_cbranch_scc1 F_pst0_f
    buffer_store_dwordx2 v[56:57], v14, s[20:23], s55 offen sc1
    buffer_store_dwordx2 v[58:59], v14, s[20:23], s55 offen offset:512 sc1
    s_add_u32 s34, s35, 0
    buffer_store_dwordx4 v[192:195], v13, s[20:23], s34 offen offset:0 sc1
    buffer_store_dwordx4 v[196:199], v13, s[20:23], s34 offen offset:1024 sc1
    buffer_store_dwordx4 v[200:203], v13, s[20:23], s34 offen offset:2048 sc1
    buffer_store_dwordx4 v[204:207], v13, s[20:23], s34 offen offset:3072 sc1
    s_add_u32 s34, s35, 4096
    buffer_store_dwordx4 v[208:211], v13, s[20:23], s34 offen offset:0 sc1
    buffer_store_dwordx4 v[212:215], v13, s[20:23], s34 offen offset:1024 sc1
    buffer_store_dwordx4 v[216:219], v13, s[20:23], s34 offen offset:2048 sc1
    buffer_store_dwordx4 v[220:223], v13, s[20:23], s34 offen offset:3072 sc1
    s_branch F_pst0_d
F_pst0_f:
    buffer_store_dwordx2 v[56:57], v14, s[20:23], s55 offen nt
    buffer_store_dwordx2 v[58:59], v14, s[20:23], s55 offen offset:512 nt
    s_add_u32 s34, s35, 0
    buffer_store_dwordx4 v[192:195], v13, s[20:23], s34 offen offset:0 nt
    buffer_store_dwordx4 v[196:199], v13, s[20:23], s34 offen offset:1024 nt
    buffer_store_dwordx4 v[200:203], v13, s[20:23], s34 offen offset:2048 nt
    buffer_store_dwordx4 v[204:207], v13, s[20:23], s34 offen offset:3072 nt
    s_add_u32 s34, s35, 4096
    buffer_store_dwordx4 v[208:211], v13, s[20:23], s34 offen offset:0 nt
    buffer_store_dwordx4 v[212:215], v13, s[20:23], s34 offen offset:1024 nt
    buffer_store_dwordx4 v[216:219], v13, s[20:23], s34 offen offset:2048 nt
    buffer_store_dwordx4 v[220:223], v13, s[20:23], s34 offen offset:3072 nt
F_pst0_d:
F_pst_done0:
    s_nop 3
    v_accvgpr_read_b32 v64, a96
    v_accvgpr_read_b32 v65, a97
    v_accvgpr_read_b32 v66, a98
    v_accvgpr_read_b32 v67, a99
    v_accvgpr_read_b32 v68, a100
    v_accvgpr_read_b32 v69, a101
    v_accvgpr_read_b32 v70, a102
    v_accvgpr_read_b32 v71, a103
    v_cvt_pk_bf16_f32 v240, v64, v65
    v_cvt_pk_bf16_f32 v241, v66, v67
    v_cvt_pk_bf16_f32 v242, v68, v69
    v_cvt_pk_bf16_f32 v243, v70, v71
    v_accvgpr_read_b32 v72, a104
    v_accvgpr_read_b32 v73, a105
    v_accvgpr_read_b32 v74, a106
    v_accvgpr_read_b32 v75, a107
    v_accvgpr_read_b32 v76, a108
    v_accvgpr_read_b32 v77, a109
    v_accvgpr_read_b32 v78, a110
    v_accvgpr_read_b32 v79, a111
    v_cvt_pk_bf16_f32 v244, v72, v73
    v_cvt_pk_bf16_f32 v245, v74, v75
    v_cvt_pk_bf16_f32 v246, v76, v77
    v_cvt_pk_bf16_f32 v247, v78, v79
    v_accvgpr_read_b32 v80, a112
    v_accvgpr_read_b32 v81, a113
    v_accvgpr_read_b32 v82, a114
    v_accvgpr_read_b32 v83, a115
    v_accvgpr_read_b32 v84, a116
    v_accvgpr_read_b32 v85, a117
    v_accvgpr_read_b32 v86, a118
    v_accvgpr_read_b32 v87, a119
    v_cvt_pk_bf16_f32 v248, v80, v81
    v_cvt_pk_bf16_f32 v249, v82, v83
    v_cvt_pk_bf16_f32 v250, v84, v85
    v_cvt_pk_bf16_f32 v251, v86, v87
    v_accvgpr_read_b32 v88, a120
    v_accvgpr_read_b32 v89, a121
    v_accvgpr_read_b32 v90, a122
    v_accvgpr_read_b32 v91, a123
    v_accvgpr_read_b32 v92, a124
    v_accvgpr_read_b32 v93, a125
    v_accvgpr_read_b32 v94, a126
    v_accvgpr_read_b32 v95, a127
    v_cvt_pk_bf16_f32 v252, v88, v89
    v_cvt_pk_bf16_f32 v253, v90, v91
    v_cvt_pk_bf16_f32 v254, v92, v93
    v_cvt_pk_bf16_f32 v255, v94, v95
    s_cmp_eq_u32 s24, s27
    s_cbranch_scc0 F_pst_remote1
    ds_write_b128 v15, v[224:227] offset:8192
    ds_write_b128 v15, v[228:231] offset:9216
    ds_write_b128 v15, v[232:235] offset:10240
    ds_write_b128 v15, v[236:239] offset:11264
    ds_write_b128 v15, v[240:243] offset:12288
    ds_write_b128 v15, v[244:247] offset:13312
    ds_write_b128 v15, v[248:251] offset:14336
    ds_write_b128 v15, v[252:255] offset:15360
    s_branch F_pst_done1
F_pst_remote1:
    s_cmp_lg_u32 s68, 0
    s_cbranch_scc1 F_pst1_f
    s_add_u32 s34, s35, 8192
    buffer_store_dwordx4 v[224:227], v13, s[20:23], s34 offen offset:0 sc1
    buffer_store_dwordx4 v[228:231], v13, s[20:23], s34 offen offset:1024 sc1
    buffer_store_dwordx4 v[232:235], v13, s[20:23], s34 offen offset:2048 sc1
    buffer_store_dwordx4 v[236:239], v13, s[20:23], s34 offen offset:3072 sc1
    s_add_u32 s34, s35, 12288
    buffer_store_dwordx4 v[240:243], v13, s[20:23], s34 offen offset:0 sc1
    buffer_store_dwordx4 v[244:247], v13, s[20:23], s34 offen offset:1024 sc1
    buffer_store_dwordx4 v[248:251], v13, s[20:23], s34 offen offset:2048 sc1
    buffer_store_dwordx4 v[252:255], v13, s[20:23], s34 offen offset:3072 sc1
    s_branch F_pst1_d
F_pst1_f:
    s_add_u32 s34, s35, 8192
    buffer_store_dwordx4 v[224:227], v13, s[20:23], s34 offen offset:0 nt
    buffer_store_dwordx4 v[228:231], v13, s[20:23], s34 offen offset:1024 nt
    buffer_store_dwordx4 v[232:235], v13, s[20:23], s34 offen offset:2048 nt
    buffer_store_dwordx4 v[236:239], v13, s[20:23], s34 offen offset:3072 nt
    s_add_u32 s34, s35, 12288
    buffer_store_dwordx4 v[240:243], v13, s[20:23], s34 offen offset:0 nt
    buffer_store_dwordx4 v[244:247], v13, s[20:23], s34 offen offset:1024 nt
    buffer_store_dwordx4 v[248:251], v13, s[20:23], s34 offen offset:2048 nt
    buffer_store_dwordx4 v[252:255], v13, s[20:23], s34 offen offset:3072 nt
F_pst1_d:
F_pst_done1:
    v_mov_b32 v61, v32
    s_cmp_eq_u32 s24, 1
    s_cbranch_scc0 F_wsel1
    v_mov_b32 v61, v33
F_wsel1:
    s_cmp_eq_u32 s24, 2
    s_cbranch_scc0 F_wsel2
    v_mov_b32 v61, v34
F_wsel2:
    s_cmp_eq_u32 s24, 3
    s_cbranch_scc0 F_wsel3
    v_mov_b32 v61, v35
F_wsel3:
    v_add_u32 v62, 0x10000, v61
    v_add_u32 v63, 0x20000, v61
    s_barrier
    ds_read_b64_tr_b16 a[0:1], v63 offset:16384
    ds_read_b64_tr_b16 a[2:3], v63 offset:18432
    ds_read_b64_tr_b16 a[4:5], v63 offset:20480
    ds_read_b64_tr_b16 a[6:7], v63 offset:22528
    ds_read_b64_tr_b16 a[8:9], v63 offset:24576
    ds_read_b64_tr_b16 a[10:11], v63 offset:26624
    ds_read_b64_tr_b16 a[12:13], v63 offset:28672
    ds_read_b64_tr_b16 a[14:15], v63 offset:30720
    ds_read_b64_tr_b16 a[16:17], v61 offset:0
    ds_read_b64_tr_b16 a[18:19], v61 offset:2048
    ds_read_b64_tr_b16 a[20:21], v61 offset:4096
    ds_read_b64_tr_b16 a[22:23], v61 offset:6144
    ds_read_b64_tr_b16 a[24:25], v61 offset:8192
    ds_read_b64_tr_b16 a[26:27], v61 offset:10240
    ds_read_b64_tr_b16 a[28:29], v61 offset:12288
    ds_read_b64_tr_b16 a[30:31], v61 offset:14336
    ds_read_b64_tr_b16 a[32:33], v61 offset:16384
    ds_read_b64_tr_b16 a[34:35], v61 offset:18432
    ds_read_b64_tr_b16 a[36:37], v61 offset:20480
    ds_read_b64_tr_b16 a[38:39], v61 offset:22528
    ds_read_b64_tr_b16 a[40:41], v61 offset:24576
    ds_read_b64_tr_b16 a[42:43], v61 offset:26624
    ds_read_b64_tr_b16 a[44:45], v61 offset:28672
    ds_read_b64_tr_b16 a[46:47], v61 offset:30720
    ds_read_b64_tr_b16 a[48:49], v61 offset:32768
    ds_read_b64_tr_b16 a[50:51], v61 offset:34816
    ds_read_b64_tr_b16 a[52:53], v61 offset:36864
    ds_read_b64_tr_b16 a[54:55], v61 offset:38912
    ds_read_b64_tr_b16 a[56:57], v61 offset:40960
    ds_read_b64_tr_b16 a[58:59], v61 offset:43008
    ds_read_b64_tr_b16 a[60:61], v61 offset:45056
    ds_read_b64_tr_b16 a[62:63], v61 offset:47104
    ds_read_b64_tr_b16 a[64:65], v61 offset:49152
    ds_read_b64_tr_b16 a[66:67], v61 offset:51200
    ds_read_b64_tr_b16 a[68:69], v61 offset:53248
    ds_read_b64_tr_b16 a[70:71], v61 offset:55296
    ds_read_b64_tr_b16 a[72:73], v61 offset:57344
    ds_read_b64_tr_b16 a[74:75], v61 offset:59392
    ds_read_b64_tr_b16 a[76:77], v61 offset:61440
    ds_read_b64_tr_b16 a[78:79], v61 offset:63488
    ds_read_b64_tr_b16 a[80:81], v62 offset:0
    ds_read_b64_tr_b16 a[82:83], v62 offset:2048
    ds_read_b64_tr_b16 a[84:85], v62 offset:4096
    ds_read_b64_tr_b16 a[86:87], v62 offset:6144
    ds_read_b64_tr_b16 a[88:89], v62 offset:8192
    ds_read_b64_tr_b16 a[90:91], v62 offset:10240
    ds_read_b64_tr_b16 a[92:93], v62 offset:12288
    ds_read_b64_tr_b16 a[94:95], v62 offset:14336
    ds_read_b64_tr_b16 a[96:97], v62 offset:16384
    ds_read_b64_tr_b16 a[98:99], v62 offset:18432
    ds_read_b64_tr_b16 a[100:101], v62 offset:20480
    ds_read_b64_tr_b16 a[102:103], v62 offset:22528
    ds_read_b64_tr_b16 a[104:105], v62 offset:24576
    ds_read_b64_tr_b16 a[106:107], v62 offset:26624
    ds_read_b64_tr_b16 a[108:109], v62 offset:28672
    ds_read_b64_tr_b16 a[110:111], v62 offset:30720
    ds_read_b64_tr_b16 a[112:113], v62 offset:32768
    ds_read_b64_tr_b16 a[114:115], v62 offset:34816
    ds_read_b64_tr_b16 a[116:117], v62 offset:36864
    ds_read_b64_tr_b16 a[118:119], v62 offset:38912
    ds_read_b64_tr_b16 a[120:121], v62 offset:40960
    ds_read_b64_tr_b16 a[122:123], v62 offset:43008
    ds_read_b64_tr_b16 a[124:125], v62 offset:45056
    ds_read_b64_tr_b16 a[126:127], v62 offset:47104
    s_waitcnt vmcnt(0) lgkmcnt(0)
    s_barrier
    s_add_u32 s48, s64, 0x2800000
    s_addc_u32 s49, s65, 0
    s_lshl_b32 s45, s28, 9
    s_add_u32 s48, s48, s45
    s_addc_u32 s49, s49, 0
    s_cmp_eq_u32 s24, 0
    s_cbranch_scc0 F_x1_wait
    s_lshl_b32 s45, s27, 7
    v_mov_b32 v7, s45
    v_mov_b32 v8, s38
    v_mov_b32 v9, s39
    s_mov_b64 exec, 1
    s_cmp_lg_u32 s68, 0
    s_cbranch_scc1 F_x1_fl_f
    global_store_dwordx2 v7, v[8:9], s[48:49] sc1
    s_branch F_x1_fl_d
F_x1_fl_f:
    global_store_dwordx2 v7, v[8:9], s[48:49]
F_x1_fl_d:
    s_mov_b64 exec, -1
    v_and_b32 v7, 3, v2
    v_lshlrev_b32 v7, 7, v7
    s_mov_b32 s44, 0
F_x1_poll:
    global_load_dwordx2 v[8:9], v7, s[48:49] sc1
    s_waitcnt vmcnt(0)
    v_cmp_eq_u32 vcc, s38, v8
    v_cmp_eq_u32 s[46:47], s39, v9
    s_add_u32 s44, s44, 1
    s_nop 2
    s_and_b64 vcc, vcc, s[46:47]
    s_cmp_eq_u64 vcc, -1
    s_cbranch_scc1 F_x1_poll_ok
    s_cmp_lt_u32 s44, 300000
    s_cbranch_scc1 F_x1_poll
F_x1_poll_ok:
F_x1_wait:
    s_lshl_b32 s35, s28, 2
    s_add_u32 s35, s35, s27
    s_lshl_b32 s35, s35, 2
    s_mul_i32 s35, s35, 0x4400
    s_add_u32 s35, s35, 0x800000
    s_lshl_b32 s45, s24, 12
    s_add_u32 s40, s27, 1
    s_and_b32 s40, s40, 3
    s_mul_i32 s40, s40, 0x4400
    s_add_u32 s41, s40, s35
    s_add_u32 s40, s27, 2
    s_and_b32 s40, s40, 3
    s_mul_i32 s40, s40, 0x4400
    s_add_u32 s42, s40, s35
    s_add_u32 s40, s27, 3
    s_and_b32 s40, s40, 3
    s_mul_i32 s40, s40, 0x4400
    s_add_u32 s43, s40, s35
    v_add_u32 v15, s45, v13
    v_add_u32 v15, 114688, v15
    v_add_u32 v60, 131072, v14
    s_barrier
    s_add_u32 s40, s41, 16384
    buffer_load_dwordx2 v[20:21], v14, s[20:23], s40 offen offset:0 sc1
    buffer_load_dwordx2 v[22:23], v14, s[20:23], s40 offen offset:512 sc1
    s_add_u32 s40, s42, 16384
    buffer_load_dwordx2 v[24:25], v14, s[20:23], s40 offen offset:0 sc1
    buffer_load_dwordx2 v[26:27], v14, s[20:23], s40 offen offset:512 sc1
    s_add_u32 s40, s43, 16384
    buffer_load_dwordx2 v[28:29], v14, s[20:23], s40 offen offset:0 sc1
    buffer_load_dwordx2 v[30:31], v14, s[20:23], s40 offen offset:512 sc1
    s_mov_b32 s40, s67
    buffer_load_dwordx4 v[144:147], v13, s[20:23], s40 offen offset:0 sc1
    buffer_load_dwordx4 v[148:151], v13, s[20:23], s40 offen offset:1024 sc1
    buffer_load_dwordx4 v[152:155], v13, s[20:23], s40 offen offset:2048 sc1
    buffer_load_dwordx4 v[156:159], v13, s[20:23], s40 offen offset:3072 sc1
    s_mov_b32 s40, s66
    buffer_load_dwordx4 v[160:163], v13, s[20:23], s40 offen offset:0 sc1
    buffer_load_dwordx4 v[164:167], v13, s[20:23], s40 offen offset:1024 sc1
    buffer_load_dwordx4 v[168:171], v13, s[20:23], s40 offen offset:2048 sc1
    buffer_load_dwordx4 v[172:175], v13, s[20:23], s40 offen offset:3072 sc1
    s_add_u32 s40, s43, s45
    buffer_load_dwordx4 v[176:179], v13, s[20:23], s40 offen offset:0 sc1
    buffer_load_dwordx4 v[180:183], v13, s[20:23], s40 offen offset:1024 sc1
    buffer_load_dwordx4 v[184:187], v13, s[20:23], s40 offen offset:2048 sc1
    buffer_load_dwordx4 v[188:191], v13, s[20:23], s40 offen offset:3072 sc1
    ds_read_b64 v[16:17], v60 offset:0
    ds_read_b64 v[18:19], v60 offset:512
    ds_read_b128 v[128:131], v15 offset:0
    ds_read_b128 v[132:135], v15 offset:1024
    ds_read_b128 v[136:139], v15 offset:2048
    ds_read_b128 v[140:143], v15 offset:3072
    s_lshl_b32 s40, s27, 14
    s_lshl_b32 s41, s24, 12
    s_add_u32 s40, s40, s41
    v_add_u32 v62, s40, v13
    s_waitcnt vmcnt(12)
    s_waitcnt lgkmcnt(4)
    s_nop 0
    v_max3_f32 v32, v16, v20, v24
    v_max_f32 v32, v32, v28
    v_sub_f32 v40, v16, v32
    v_sub_f32 v42, v20, v32
    v_sub_f32 v44, v24, v32
    v_sub_f32 v46, v28, v32
    v_exp_f32 v40, v40
    v_exp_f32 v42, v42
    v_exp_f32 v44, v44
    v_exp_f32 v46, v46
    s_nop 0
    v_mul_f32 v33, v40, v17
    v_fmac_f32 v33, v42, v21
    v_fmac_f32 v33, v44, v25
    v_fmac_f32 v33, v46, v29
    v_rcp_f32 v33, v33
    s_nop 0
    v_mul_f32 v40, v40, v33
    v_mul_f32 v42, v42, v33
    v_mul_f32 v44, v44, v33
    v_mul_f32 v46, v46, v33
    v_max3_f32 v32, v18, v22, v26
    v_max_f32 v32, v32, v30
    v_sub_f32 v41, v18, v32
    v_sub_f32 v43, v22, v32
    v_sub_f32 v45, v26, v32
    v_sub_f32 v47, v30, v32
    v_exp_f32 v41, v41
    v_exp_f32 v43, v43
    v_exp_f32 v45, v45
    v_exp_f32 v47, v47
    s_nop 0
    v_mul_f32 v33, v41, v19
    v_fmac_f32 v33, v43, v23
    v_fmac_f32 v33, v45, v27
    v_fmac_f32 v33, v47, v31
    v_rcp_f32 v33, v33
    s_nop 0
    v_mul_f32 v41, v41, v33
    v_mul_f32 v43, v43, v33
    v_mul_f32 v45, v45, v33
    v_mul_f32 v47, v47, v33
    s_waitcnt lgkmcnt(0)
    s_nop 0
    v_lshlrev_b32 v34, 16, v128
    v_and_b32 v35, 0xffff0000, v128
    v_mul_f32 v96, v34, v40
    v_mul_f32 v97, v35, v40
    v_lshlrev_b32 v36, 16, v129
    v_and_b32 v37, 0xffff0000, v129
    v_mul_f32 v98, v36, v40
    v_mul_f32 v99, v37, v40
    v_lshlrev_b32 v34, 16, v130
    v_and_b32 v35, 0xffff0000, v130
    v_mul_f32 v100, v34, v40
    v_mul_f32 v101, v35, v40
    v_lshlrev_b32 v36, 16, v131
    v_and_b32 v37, 0xffff0000, v131
    v_mul_f32 v102, v36, v40
    v_mul_f32 v103, v37, v40
    v_lshlrev_b32 v34, 16, v132
    v_and_b32 v35, 0xffff0000, v132
    v_mul_f32 v104, v34, v40
    v_mul_f32 v105, v35, v40
    v_lshlrev_b32 v36, 16, v133
    v_and_b32 v37, 0xffff0000, v133
    v_mul_f32 v106, v36, v40
    v_mul_f32 v107, v37, v40
    v_lshlrev_b32 v34, 16, v134
    v_and_b32 v35, 0xffff0000, v134
    v_mul_f32 v108, v34, v40
    v_mul_f32 v109, v35, v40
    v_lshlrev_b32 v36, 16, v135
    v_and_b32 v37, 0xffff0000, v135
    v_mul_f32 v110, v36, v40
    v_mul_f32 v111, v37, v40
    v_lshlrev_b32 v34, 16, v136
    v_and_b32 v35, 0xffff0000, v136
    v_mul_f32 v112, v34, v41
    v_mul_f32 v113, v35, v41
    v_lshlrev_b32 v36, 16, v137
    v_and_b32 v37, 0xffff0000, v137
    v_mul_f32 v114, v36, v41
    v_mul_f32 v115, v37, v41
    v_lshlrev_b32 v34, 16, v138
    v_and_b32 v35, 0xffff0000, v138
    v_mul_f32 v116, v34, v41
    v_mul_f32 v117, v35, v41
    v_lshlrev_b32 v36, 16, v139
    v_and_b32 v37, 0xffff0000, v139
    v_mul_f32 v118, v36, v41
    v_mul_f32 v119, v37, v41
    v_lshlrev_b32 v34, 16, v140
    v_and_b32 v35, 0xffff0000, v140
    v_mul_f32 v120, v34, v41
    v_mul_f32 v121, v35, v41
    v_lshlrev_b32 v36, 16, v141
    v_and_b32 v37, 0xffff0000, v141
    v_mul_f32 v122, v36, v41
    v_mul_f32 v123, v37, v41
    v_lshlrev_b32 v34, 16, v142
    v_and_b32 v35, 0xffff0000, v142
    v_mul_f32 v124, v34, v41
    v_mul_f32 v125, v35, v41
    v_lshlrev_b32 v36, 16, v143
    v_and_b32 v37, 0xffff0000, v143
    v_mul_f32 v126, v36, v41
    v_mul_f32 v127, v37, v41
    s_waitcnt vmcnt(8)
    v_lshlrev_b32 v34, 16, v144
    v_and_b32 v35, 0xffff0000, v144
    v_fmac_f32 v96, v34, v42
    v_fmac_f32 v97, v35, v42
    v_lshlrev_b32 v36, 16, v145
    v_and_b32 v37, 0xffff0000, v145
    v_fmac_f32 v98, v36, v42
    v_fmac_f32 v99, v37, v42
    v_lshlrev_b32 v34, 16, v146
    v_and_b32 v35, 0xffff0000, v146
    v_fmac_f32 v100, v34, v42
    v_fmac_f32 v101, v35, v42
    v_lshlrev_b32 v36, 16, v147
    v_and_b32 v37, 0xffff0000, v147
    v_fmac_f32 v102, v36, v42
    v_fmac_f32 v103, v37, v42
    v_lshlrev_b32 v34, 16, v148
    v_and_b32 v35, 0xffff0000, v148
    v_fmac_f32 v104, v34, v42
    v_fmac_f32 v105, v35, v42
    v_lshlrev_b32 v36, 16, v149
    v_and_b32 v37, 0xffff0000, v149
    v_fmac_f32 v106, v36, v42
    v_fmac_f32 v107, v37, v42
    v_lshlrev_b32 v34, 16, v150
    v_and_b32 v35, 0xffff0000, v150
    v_fmac_f32 v108, v34, v42
    v_fmac_f32 v109, v35, v42
    v_lshlrev_b32 v36, 16, v151
    v_and_b32 v37, 0xffff0000, v151
    v_fmac_f32 v110, v36, v42
    v_fmac_f32 v111, v37, v42
    v_lshlrev_b32 v34, 16, v152
    v_and_b32 v35, 0xffff0000, v152
    v_fmac_f32 v112, v34, v43
    v_fmac_f32 v113, v35, v43
    v_lshlrev_b32 v36, 16, v153
    v_and_b32 v37, 0xffff0000, v153
    v_fmac_f32 v114, v36, v43
    v_fmac_f32 v115, v37, v43
    v_lshlrev_b32 v34, 16, v154
    v_and_b32 v35, 0xffff0000, v154
    v_fmac_f32 v116, v34, v43
    v_fmac_f32 v117, v35, v43
    v_lshlrev_b32 v36, 16, v155
    v_and_b32 v37, 0xffff0000, v155
    v_fmac_f32 v118, v36, v43
    v_fmac_f32 v119, v37, v43
    v_lshlrev_b32 v34, 16, v156
    v_and_b32 v35, 0xffff0000, v156
    v_fmac_f32 v120, v34, v43
    v_fmac_f32 v121, v35, v43
    v_lshlrev_b32 v36, 16, v157
    v_and_b32 v37, 0xffff0000, v157
    v_fmac_f32 v122, v36, v43
    v_fmac_f32 v123, v37, v43
    v_lshlrev_b32 v34, 16, v158
    v_and_b32 v35, 0xffff0000, v158
    v_fmac_f32 v124, v34, v43
    v_fmac_f32 v125, v35, v43
    v_lshlrev_b32 v36, 16, v159
    v_and_b32 v37, 0xffff0000, v159
    v_fmac_f32 v126, v36, v43
    v_fmac_f32 v127, v37, v43
    s_waitcnt vmcnt(4)
    v_lshlrev_b32 v34, 16, v160
    v_and_b32 v35, 0xffff0000, v160
    v_fmac_f32 v96, v34, v44
    v_fmac_f32 v97, v35, v44
    v_lshlrev_b32 v36, 16, v161
    v_and_b32 v37, 0xffff0000, v161
    v_fmac_f32 v98, v36, v44
    v_fmac_f32 v99, v37, v44
    v_lshlrev_b32 v34, 16, v162
    v_and_b32 v35, 0xffff0000, v162
    v_fmac_f32 v100, v34, v44
    v_fmac_f32 v101, v35, v44
    v_lshlrev_b32 v36, 16, v163
    v_and_b32 v37, 0xffff0000, v163
    v_fmac_f32 v102, v36, v44
    v_fmac_f32 v103, v37, v44
    v_lshlrev_b32 v34, 16, v164
    v_and_b32 v35, 0xffff0000, v164
    v_fmac_f32 v104, v34, v44
    v_fmac_f32 v105, v35, v44
    v_lshlrev_b32 v36, 16, v165
    v_and_b32 v37, 0xffff0000, v165
    v_fmac_f32 v106, v36, v44
    v_fmac_f32 v107, v37, v44
    v_lshlrev_b32 v34, 16, v166
    v_and_b32 v35, 0xffff0000, v166
    v_fmac_f32 v108, v34, v44
    v_fmac_f32 v109, v35, v44
    v_lshlrev_b32 v36, 16, v167
    v_and_b32 v37, 0xffff0000, v167
    v_fmac_f32 v110, v36, v44
    v_fmac_f32 v111, v37, v44
    v_lshlrev_b32 v34, 16, v168
    v_and_b32 v35, 0xffff0000, v168
    v_fmac_f32 v112, v34, v45
    v_fmac_f32 v113, v35, v45
    v_lshlrev_b32 v36, 16, v169
    v_and_b32 v37, 0xffff0000, v169
    v_fmac_f32 v114, v36, v45
    v_fmac_f32 v115, v37, v45
    v_lshlrev_b32 v34, 16, v170
    v_and_b32 v35, 0xffff0000, v170
    v_fmac_f32 v116, v34, v45
    v_fmac_f32 v117, v35, v45
    v_lshlrev_b32 v36, 16, v171
    v_and_b32 v37, 0xffff0000, v171
    v_fmac_f32 v118, v36, v45
    v_fmac_f32 v119, v37, v45
    v_lshlrev_b32 v34, 16, v172
    v_and_b32 v35, 0xffff0000, v172
    v_fmac_f32 v120, v34, v45
    v_fmac_f32 v121, v35, v45
    v_lshlrev_b32 v36, 16, v173
    v_and_b32 v37, 0xffff0000, v173
    v_fmac_f32 v122, v36, v45
    v_fmac_f32 v123, v37, v45
    v_lshlrev_b32 v34, 16, v174
    v_and_b32 v35, 0xffff0000, v174
    v_fmac_f32 v124, v34, v45
    v_fmac_f32 v125, v35, v45
    v_lshlrev_b32 v36, 16, v175
    v_and_b32 v37, 0xffff0000, v175
    v_fmac_f32 v126, v36, v45
    v_fmac_f32 v127, v37, v45
    s_waitcnt vmcnt(0)
    v_lshlrev_b32 v34, 16, v176
    v_and_b32 v35, 0xffff0000, v176
    v_fmac_f32 v96, v34, v46
    v_fmac_f32 v97, v35, v46
    v_lshlrev_b32 v36, 16, v177
    v_and_b32 v37, 0xffff0000, v177
    v_fmac_f32 v98, v36, v46
    v_fmac_f32 v99, v37, v46
    v_lshlrev_b32 v34, 16, v178
    v_and_b32 v35, 0xffff0000, v178
    v_fmac_f32 v100, v34, v46
    v_fmac_f32 v101, v35, v46
    v_lshlrev_b32 v36, 16, v179
    v_and_b32 v37, 0xffff0000, v179
    v_fmac_f32 v102, v36, v46
    v_fmac_f32 v103, v37, v46
    v_lshlrev_b32 v34, 16, v180
    v_and_b32 v35, 0xffff0000, v180
    v_fmac_f32 v104, v34, v46
    v_fmac_f32 v105, v35, v46
    v_lshlrev_b32 v36, 16, v181
    v_and_b32 v37, 0xffff0000, v181
    v_fmac_f32 v106, v36, v46
    v_fmac_f32 v107, v37, v46
    v_lshlrev_b32 v34, 16, v182
    v_and_b32 v35, 0xffff0000, v182
    v_fmac_f32 v108, v34, v46
    v_fmac_f32 v109, v35, v46
    v_lshlrev_b32 v36, 16, v183
    v_and_b32 v37, 0xffff0000, v183
    v_fmac_f32 v110, v36, v46
    v_fmac_f32 v111, v37, v46
    v_lshlrev_b32 v34, 16, v184
    v_and_b32 v35, 0xffff0000, v184
    v_fmac_f32 v112, v34, v47
    v_fmac_f32 v113, v35, v47
    v_lshlrev_b32 v36, 16, v185
    v_and_b32 v37, 0xffff0000, v185
    v_fmac_f32 v114, v36, v47
    v_fmac_f32 v115, v37, v47
    v_lshlrev_b32 v34, 16, v186
    v_and_b32 v35, 0xffff0000, v186
    v_fmac_f32 v116, v34, v47
    v_fmac_f32 v117, v35, v47
    v_lshlrev_b32 v36, 16, v187
    v_and_b32 v37, 0xffff0000, v187
    v_fmac_f32 v118, v36, v47
    v_fmac_f32 v119, v37, v47
    v_lshlrev_b32 v34, 16, v188
    v_and_b32 v35, 0xffff0000, v188
    v_fmac_f32 v120, v34, v47
    v_fmac_f32 v121, v35, v47
    v_lshlrev_b32 v36, 16, v189
    v_and_b32 v37, 0xffff0000, v189
    v_fmac_f32 v122, v36, v47
    v_fmac_f32 v123, v37, v47
    v_lshlrev_b32 v34, 16, v190
    v_and_b32 v35, 0xffff0000, v190
    v_fmac_f32 v124, v34, v47
    v_fmac_f32 v125, v35, v47
    v_lshlrev_b32 v36, 16, v191
    v_and_b32 v37, 0xffff0000, v191
    v_fmac_f32 v126, v36, v47
    v_fmac_f32 v127, v37, v47
    v_cvt_pk_bf16_f32 v64, v96, v97
    v_cvt_pk_bf16_f32 v65, v98, v99
    v_cvt_pk_bf16_f32 v66, v100, v101
    v_cvt_pk_bf16_f32 v67, v102, v103
    v_cvt_pk_bf16_f32 v68, v104, v105
    v_cvt_pk_bf16_f32 v69, v106, v107
    v_cvt_pk_bf16_f32 v70, v108, v109
    v_cvt_pk_bf16_f32 v71, v110, v111
    v_cvt_pk_bf16_f32 v72, v112, v113
    v_cvt_pk_bf16_f32 v73, v114, v115
    v_cvt_pk_bf16_f32 v74, v116, v117
    v_cvt_pk_bf16_f32 v75, v118, v119
    v_cvt_pk_bf16_f32 v76, v120, v121
    v_cvt_pk_bf16_f32 v77, v122, v123
    v_cvt_pk_bf16_f32 v78, v124, v125
    v_cvt_pk_bf16_f32 v79, v126, v127
    s_cmp_lg_u32 s68, 0
    s_cbranch_scc1 F_ost_f
    buffer_store_dwordx4 v[64:67], v13, s[20:23], s67 offen offset:0 sc1
    buffer_store_dwordx4 v[68:71], v13, s[20:23], s67 offen offset:2048 sc1
    buffer_store_dwordx4 v[72:75], v13, s[20:23], s67 offen offset:1024 sc1
    buffer_store_dwordx4 v[76:79], v13, s[20:23], s67 offen offset:3072 sc1
    s_branch F_ost_d
F_ost_f:
    buffer_store_dwordx4 v[64:67], v13, s[20:23], s67 offen offset:0 nt
    buffer_store_dwordx4 v[68:71], v13, s[20:23], s67 offen offset:2048 nt
    buffer_store_dwordx4 v[72:75], v13, s[20:23], s67 offen offset:1024 nt
    buffer_store_dwordx4 v[76:79], v13, s[20:23], s67 offen offset:3072 nt
F_ost_d:
    ds_write_b128 v62, v[64:67] offset:0
    ds_write_b128 v62, v[68:71] offset:2048
    ds_write_b128 v62, v[72:75] offset:1024
    ds_write_b128 v62, v[76:79] offset:3072
    s_add_u32 s48, s64, 0x2850000
    s_addc_u32 s49, s65, 0
    s_lshl_b32 s45, s28, 9
    s_add_u32 s48, s48, s45
    s_addc_u32 s49, s49, 0
    s_lshl_b32 s35, s26, 5
    s_lshl_b32 s36, s25, 2
    s_add_u32 s35, s35, s36
    s_lshl_b32 s36, s24, 12
    s_add_u32 s40, s27, 1
    s_and_b32 s40, s40, 3
    s_lshl_b32 s51, s40, 14
    s_add_u32 s51, s51, s36
    s_add_u32 s40, s40, s35
    s_lshl_b32 s40, s40, 14
    s_add_u32 s40, s40, 0x400000
    s_add_u32 s41, s40, s36
    s_add_u32 s40, s27, 2
    s_and_b32 s40, s40, 3
    s_lshl_b32 s52, s40, 14
    s_add_u32 s52, s52, s36
    s_add_u32 s40, s40, s35
    s_lshl_b32 s40, s40, 14
    s_add_u32 s40, s40, 0x400000
    s_add_u32 s42, s40, s36
    s_add_u32 s40, s27, 3
    s_and_b32 s40, s40, 3
    s_lshl_b32 s53, s40, 14
    s_add_u32 s53, s53, s36
    s_add_u32 s40, s40, s35
    s_lshl_b32 s40, s40, 14
    s_add_u32 s40, s40, 0x400000
    s_add_u32 s43, s40, s36
    s_waitcnt vmcnt(0) lgkmcnt(0)
    s_barrier
    s_cmp_eq_u32 s24, 0
    s_cbranch_scc0 F_x1b_wait
    s_lshl_b32 s45, s27, 7
    v_mov_b32 v7, s45
    v_mov_b32 v8, s38
    v_mov_b32 v9, s39
    s_mov_b64 exec, 1
    s_cmp_lg_u32 s68, 0
    s_cbranch_scc1 F_x1b_fl_f
    global_store_dwordx2 v7, v[8:9], s[48:49] sc1
    s_branch F_x1b_fl_d
F_x1b_fl_f:
    global_store_dwordx2 v7, v[8:9], s[48:49]
F_x1b_fl_d:
    s_mov_b64 exec, -1
    v_and_b32 v7, 3, v2
    v_lshlrev_b32 v7, 7, v7
    s_mov_b32 s44, 0
F_x1b_poll:
    global_load_dwordx2 v[8:9], v7, s[48:49] sc1
    s_waitcnt vmcnt(0)
    v_cmp_eq_u32 vcc, s38, v8
    v_cmp_eq_u32 s[46:47], s39, v9
    s_add_u32 s44, s44, 1
    s_nop 2
    s_and_b64 vcc, vcc, s[46:47]
    s_cmp_eq_u64 vcc, -1
    s_cbranch_scc1 F_x1b_poll_ok
    s_cmp_lt_u32 s44, 300000
    s_cbranch_scc1 F_x1b_poll
F_x1b_poll_ok:
F_x1b_wait:
    s_barrier
    s_add_u32 m0, s51, 0
    s_nop 0
    buffer_load_dwordx4 v13, s[20:23], s41 offen offset:0 sc1 lds
    buffer_load_dwordx4 v13, s[20:23], s41 offen offset:1024 sc1 lds
    buffer_load_dwordx4 v13, s[20:23], s41 offen offset:2048 sc1 lds
    buffer_load_dwordx4 v13, s[20:23], s41 offen offset:3072 sc1 lds
    s_add_u32 m0, s52, 0
    s_nop 0
    buffer_load_dwordx4 v13, s[20:23], s42 offen offset:0 sc1 lds
    buffer_load_dwordx4 v13, s[20:23], s42 offen offset:1024 sc1 lds
    buffer_load_dwordx4 v13, s[20:23], s42 offen offset:2048 sc1 lds
    buffer_load_dwordx4 v13, s[20:23], s42 offen offset:3072 sc1 lds
    s_add_u32 m0, s53, 0
    s_nop 0
    buffer_load_dwordx4 v13, s[20:23], s43 offen offset:0 sc1 lds
    buffer_load_dwordx4 v13, s[20:23], s43 offen offset:1024 sc1 lds
    buffer_load_dwordx4 v13, s[20:23], s43 offen offset:2048 sc1 lds
    buffer_load_dwordx4 v13, s[20:23], s43 offen offset:3072 sc1 lds
    s_lshl_b32 s35, s26, 2
    s_add_u32 s35, s35, s27
    s_lshl_b32 s35, s35, 18
    s_add_u32 s35, s35, 0x1a00000
    s_lshl_b32 s36, s24, 10
    s_add_u32 s35, s35, s36
    s_lshl_b32 s36, s25, 12
    s_add_u32 s50, s35, s36
    s_lshl_b32 s36, s25, 15
    s_add_u32 s51, s35, s36
    s_waitcnt vmcnt(0)
    s_barrier
    s_add_u32 s36, s26, 0
    s_and_b32 s36, s36, 7
    s_lshl_b32 s36, s36, 13
    v_add_u32 v62, s36, v13
    ds_read_b128 v[64:67], v62 offset:0
    ds_read_b128 v[68:71], v62 offset:2048
    ds_read_b128 v[72:75], v62 offset:4096
    ds_read_b128 v[76:79], v62 offset:6144
    s_add_u32 s36, s26, 1
    s_and_b32 s36, s36, 7
    s_lshl_b32 s36, s36, 13
    v_add_u32 v63, s36, v13
    ds_read_b128 v[80:83], v63 offset:0
    ds_read_b128 v[84:87], v63 offset:2048
    ds_read_b128 v[88:91], v63 offset:4096
    ds_read_b128 v[92:95], v63 offset:6144
    s_waitcnt lgkmcnt(7)
    v_mfma_f32_32x32x16_bf16 v[16:31], a[0:3], v[64:67], 0
    s_add_u32 s36, s26, 2
    s_and_b32 s36, s36, 7
    s_lshl_b32 s36, s36, 13
    v_add_u32 v62, s36, v13
    ds_read_b128 v[96:99], v62 offset:0
    s_waitcnt lgkmcnt(7)
    v_mfma_f32_32x32x16_bf16 v[16:31], a[4:7], v[68:71], v[16:31]
    ds_read_b128 v[100:103], v62 offset:2048
    s_waitcnt lgkmcnt(7)
    v_mfma_f32_32x32x16_bf16 v[16:31], a[8:11], v[72:75], v[16:31]
    ds_read_b128 v[104:107], v62 offset:4096
    s_waitcnt lgkmcnt(7)
    v_mfma_f32_32x32x16_bf16 v[16:31], a[12:15], v[76:79], v[16:31]
    ds_read_b128 v[108:111], v62 offset:6144
    s_waitcnt lgkmcnt(7)
    v_mfma_f32_32x32x16_bf16 v[16:31], a[16:19], v[80:83], v[16:31]
    s_add_u32 s36, s26, 3
    s_and_b32 s36, s36, 7
    s_lshl_b32 s36, s36, 13
    v_add_u32 v63, s36, v13
    ds_read_b128 v[112:115], v63 offset:0
    s_waitcnt lgkmcnt(7)
    v_mfma_f32_32x32x16_bf16 v[16:31], a[20:23], v[84:87], v[16:31]
    ds_read_b128 v[116:119], v63 offset:2048
    s_waitcnt lgkmcnt(7)
    v_mfma_f32_32x32x16_bf16 v[16:31], a[24:27], v[88:91], v[16:31]
    ds_read_b128 v[120:123], v63 offset:4096
    s_waitcnt lgkmcnt(7)
    v_mfma_f32_32x32x16_bf16 v[16:31], a[28:31], v[92:95], v[16:31]
    ds_read_b128 v[124:127], v63 offset:6144
    s_waitcnt lgkmcnt(7)
    v_mfma_f32_32x32x16_bf16 v[16:31], a[32:35], v[96:99], v[16:31]
    s_add_u32 s36, s26, 4
    s_and_b32 s36, s36, 7
    s_lshl_b32 s36, s36, 13
    v_add_u32 v62, s36, v13
    ds_read_b128 v[64:67], v62 offset:0
    s_waitcnt lgkmcnt(7)
    v_mfma_f32_32x32x16_bf16 v[16:31], a[36:39], v[100:103], v[16:31]
    ds_read_b128 v[68:71], v62 offset:2048
    s_waitcnt lgkmcnt(7)
    v_mfma_f32_32x32x16_bf16 v[16:31], a[40:43], v[104:107], v[16:31]
    ds_read_b128 v[72:75], v62 offset:4096
    s_waitcnt lgkmcnt(7)
    v_mfma_f32_32x32x16_bf16 v[16:31], a[44:47], v[108:111], v[16:31]
    ds_read_b128 v[76:79], v62 offset:6144
    s_waitcnt lgkmcnt(7)
    v_mfma_f32_32x32x16_bf16 v[16:31], a[48:51], v[112:115], v[16:31]
    s_add_u32 s36, s26, 5
    s_and_b32 s36, s36, 7
    s_lshl_b32 s36, s36, 13
    v_add_u32 v63, s36, v13
    ds_read_b128 v[80:83], v63 offset:0
    s_waitcnt lgkmcnt(7)
    v_mfma_f32_32x32x16_bf16 v[16:31], a[52:55], v[116:119], v[16:31]
    ds_read_b128 v[84:87], v63 offset:2048
    s_waitcnt lgkmcnt(7)
    v_mfma_f32_32x32x16_bf16 v[16:31], a[56:59], v[120:123], v[16:31]
    ds_read_b128 v[88:91], v63 offset:4096
    s_waitcnt lgkmcnt(7)
    v_mfma_f32_32x32x16_bf16 v[16:31], a[60:63], v[124:127], v[16:31]
    ds_read_b128 v[92:95], v63 offset:6144
    s_waitcnt lgkmcnt(7)
    v_mfma_f32_32x32x16_bf16 v[16:31], a[64:67], v[64:67], v[16:31]
    s_add_u32 s36, s26, 6
    s_and_b32 s36, s36, 7
    s_lshl_b32 s36, s36, 13
    v_add_u32 v62, s36, v13
    ds_read_b128 v[96:99], v62 offset:0
    s_waitcnt lgkmcnt(7)
    v_mfma_f32_32x32x16_bf16 v[16:31], a[68:71], v[68:71], v[16:31]
    ds_read_b128 v[100:103], v62 offset:2048
    s_waitcnt lgkmcnt(7)
    v_mfma_f32_32x32x16_bf16 v[16:31], a[72:75], v[72:75], v[16:31]
    ds_read_b128 v[104:107], v62 offset:4096
    s_waitcnt lgkmcnt(7)
    v_mfma_f32_32x32x16_bf16 v[16:31], a[76:79], v[76:79], v[16:31]
    ds_read_b128 v[108:111], v62 offset:6144
    s_waitcnt lgkmcnt(7)
    v_mfma_f32_32x32x16_bf16 v[16:31], a[80:83], v[80:83], v[16:31]
    s_add_u32 s36, s26, 7
    s_and_b32 s36, s36, 7
    s_lshl_b32 s36, s36, 13
    v_add_u32 v63, s36, v13
    ds_read_b128 v[112:115], v63 offset:0
    s_waitcnt lgkmcnt(7)
    v_mfma_f32_32x32x16_bf16 v[16:31], a[84:87], v[84:87], v[16:31]
    ds_read_b128 v[116:119], v63 offset:2048
    s_waitcnt lgkmcnt(7)
    v_mfma_f32_32x32x16_bf16 v[16:31], a[88:91], v[88:91], v[16:31]
    ds_read_b128 v[120:123], v63 offset:4096
    s_waitcnt lgkmcnt(7)
    v_mfma_f32_32x32x16_bf16 v[16:31], a[92:95], v[92:95], v[16:31]
    ds_read_b128 v[124:127], v63 offset:6144
    s_waitcnt lgkmcnt(7)
    v_mfma_f32_32x32x16_bf16 v[16:31], a[96:99], v[96:99], v[16:31]
    s_add_u32 s36, s26, 0
    s_and_b32 s36, s36, 7
    s_lshl_b32 s36, s36, 13
    v_add_u32 v62, s36, v13
    ds_read_b128 v[64:67], v62 offset:1024
    s_waitcnt lgkmcnt(7)
    v_mfma_f32_32x32x16_bf16 v[16:31], a[100:103], v[100:103], v[16:31]
    ds_read_b128 v[68:71], v62 offset:3072
    s_waitcnt lgkmcnt(7)
    v_mfma_f32_32x32x16_bf16 v[16:31], a[104:107], v[104:107], v[16:31]
    ds_read_b128 v[72:75], v62 offset:5120
    s_waitcnt lgkmcnt(7)
    v_mfma_f32_32x32x16_bf16 v[16:31], a[108:111], v[108:111], v[16:31]
    ds_read_b128 v[76:79], v62 offset:7168
    s_waitcnt lgkmcnt(7)
    v_mfma_f32_32x32x16_bf16 v[16:31], a[112:115], v[112:115], v[16:31]
    s_add_u32 s36, s26, 1
    s_and_b32 s36, s36, 7
    s_lshl_b32 s36, s36, 13
    v_add_u32 v63, s36, v13
    ds_read_b128 v[80:83], v63 offset:1024
    s_waitcnt lgkmcnt(7)
    v_mfma_f32_32x32x16_bf16 v[16:31], a[116:119], v[116:119], v[16:31]
    ds_read_b128 v[84:87], v63 offset:3072
    s_waitcnt lgkmcnt(7)
    v_mfma_f32_32x32x16_bf16 v[16:31], a[120:123], v[120:123], v[16:31]
    ds_read_b128 v[88:91], v63 offset:5120
    s_waitcnt lgkmcnt(7)
    v_mfma_f32_32x32x16_bf16 v[16:31], a[124:127], v[124:127], v[16:31]
    ds_read_b128 v[92:95], v63 offset:7168
    s_waitcnt lgkmcnt(7)
    v_mfma_f32_32x32x16_bf16 v[32:47], a[0:3], v[64:67], 0
    s_add_u32 s36, s26, 2
    s_and_b32 s36, s36, 7
    s_lshl_b32 s36, s36, 13
    v_add_u32 v62, s36, v13
    ds_read_b128 v[96:99], v62 offset:1024
    s_waitcnt lgkmcnt(7)
    v_mfma_f32_32x32x16_bf16 v[32:47], a[4:7], v[68:71], v[32:47]
    ds_read_b128 v[100:103], v62 offset:3072
    s_waitcnt lgkmcnt(7)
    v_mfma_f32_32x32x16_bf16 v[32:47], a[8:11], v[72:75], v[32:47]
    ds_read_b128 v[104:107], v62 offset:5120
    s_waitcnt lgkmcnt(7)
    v_mfma_f32_32x32x16_bf16 v[32:47], a[12:15], v[76:79], v[32:47]
    ds_read_b128 v[108:111], v62 offset:7168
    s_waitcnt lgkmcnt(7)
    v_mfma_f32_32x32x16_bf16 v[32:47], a[16:19], v[80:83], v[32:47]
    s_add_u32 s36, s26, 3
    s_and_b32 s36, s36, 7
    s_lshl_b32 s36, s36, 13
    v_add_u32 v63, s36, v13
    ds_read_b128 v[112:115], v63 offset:1024
    v_cvt_pk_bf16_f32 v129, v16, v17
    v_cvt_pk_bf16_f32 v130, v18, v19
    v_mov_b32 v128, s38
    s_waitcnt lgkmcnt(7)
    v_mfma_f32_32x32x16_bf16 v[32:47], a[20:23], v[84:87], v[32:47]
    ds_read_b128 v[116:119], v63 offset:3072
    v_mov_b32 v131, s39
    s_add_u32 s34, s50, 0
    buffer_store_dwordx4 v[128:131], v13, s[20:23], s34 offen sc1
    s_waitcnt lgkmcnt(7)
    v_mfma_f32_32x32x16_bf16 v[32:47], a[24:27], v[88:91], v[32:47]
    ds_read_b128 v[120:123], v63 offset:5120
    v_cvt_pk_bf16_f32 v133, v20, v21
    v_cvt_pk_bf16_f32 v134, v22, v23
    v_mov_b32 v132, s38
    s_waitcnt lgkmcnt(7)
    v_mfma_f32_32x32x16_bf16 v[32:47], a[28:31], v[92:95], v[32:47]
    ds_read_b128 v[124:127], v63 offset:7168
    v_mov_b32 v135, s39
    s_add_u32 s34, s50, 32768
    buffer_store_dwordx4 v[132:135], v13, s[20:23], s34 offen sc1
    s_waitcnt lgkmcnt(7)
    v_mfma_f32_32x32x16_bf16 v[32:47], a[32:35], v[96:99], v[32:47]
    s_add_u32 s36, s26, 4
    s_and_b32 s36, s36, 7
    s_lshl_b32 s36, s36, 13
    v_add_u32 v62, s36, v13
    ds_read_b128 v[64:67], v62 offset:1024
    v_cvt_pk_bf16_f32 v137, v24, v25
    v_cvt_pk_bf16_f32 v138, v26, v27
    v_mov_b32 v136, s38
    s_waitcnt lgkmcnt(7)
    v_mfma_f32_32x32x16_bf16 v[32:47], a[36:39], v[100:103], v[32:47]
    ds_read_b128 v[68:71], v62 offset:3072
    v_mov_b32 v139, s39
    s_add_u32 s34, s50, 65536
    buffer_store_dwordx4 v[136:139], v13, s[20:23], s34 offen sc1
    s_waitcnt lgkmcnt(7)
    v_mfma_f32_32x32x16_bf16 v[32:47], a[40:43], v[104:107], v[32:47]
    ds_read_b128 v[72:75], v62 offset:5120
    v_cvt_pk_bf16_f32 v141, v28, v29
    v_cvt_pk_bf16_f32 v142, v30, v31
    v_mov_b32 v140, s38
    s_waitcnt lgkmcnt(7)
    v_mfma_f32_32x32x16_bf16 v[32:47], a[44:47], v[108:111], v[32:47]
    ds_read_b128 v[76:79], v62 offset:7168
    v_mov_b32 v143, s39
    s_add_u32 s34, s50, 98304
    buffer_store_dwordx4 v[140:143], v13, s[20:23], s34 offen sc1
    s_waitcnt lgkmcnt(7)
    v_mfma_f32_32x32x16_bf16 v[32:47], a[48:51], v[112:115], v[32:47]
    s_add_u32 s36, s26, 5
    s_and_b32 s36, s36, 7
    s_lshl_b32 s36, s36, 13
    v_add_u32 v63, s36, v13
    ds_read_b128 v[80:83], v63 offset:1024
    s_waitcnt lgkmcnt(7)
    v_mfma_f32_32x32x16_bf16 v[32:47], a[52:55], v[116:119], v[32:47]
    ds_read_b128 v[84:87], v63 offset:3072
    s_waitcnt lgkmcnt(7)
    v_mfma_f32_32x32x16_bf16 v[32:47], a[56:59], v[120:123], v[32:47]
    ds_read_b128 v[88:91], v63 offset:5120
    s_waitcnt lgkmcnt(7)
    v_mfma_f32_32x32x16_bf16 v[32:47], a[60:63], v[124:127], v[32:47]
    ds_read_b128 v[92:95], v63 offset:7168
    s_waitcnt lgkmcnt(7)
    v_mfma_f32_32x32x16_bf16 v[32:47], a[64:67], v[64:67], v[32:47]
    s_add_u32 s36, s26, 6
    s_and_b32 s36, s36, 7
    s_lshl_b32 s36, s36, 13
    v_add_u32 v62, s36, v13
    ds_read_b128 v[96:99], v62 offset:1024
    s_waitcnt lgkmcnt(7)
    v_mfma_f32_32x32x16_bf16 v[32:47], a[68:71], v[68:71], v[32:47]
    ds_read_b128 v[100:103], v62 offset:3072
    s_waitcnt lgkmcnt(7)
    v_mfma_f32_32x32x16_bf16 v[32:47], a[72:75], v[72:75], v[32:47]
    ds_read_b128 v[104:107], v62 offset:5120
    s_waitcnt lgkmcnt(7)
    v_mfma_f32_32x32x16_bf16 v[32:47], a[76:79], v[76:79], v[32:47]
    ds_read_b128 v[108:111], v62 offset:7168
    s_waitcnt lgkmcnt(7)
    v_mfma_f32_32x32x16_bf16 v[32:47], a[80:83], v[80:83], v[32:47]
    s_add_u32 s36, s26, 7
    s_and_b32 s36, s36, 7
    s_lshl_b32 s36, s36, 13
    v_add_u32 v63, s36, v13
    ds_read_b128 v[112:115], v63 offset:1024
    s_waitcnt lgkmcnt(7)
    v_mfma_f32_32x32x16_bf16 v[32:47], a[84:87], v[84:87], v[32:47]
    ds_read_b128 v[116:119], v63 offset:3072
    s_waitcnt lgkmcnt(7)
    v_mfma_f32_32x32x16_bf16 v[32:47], a[88:91], v[88:91], v[32:47]
    ds_read_b128 v[120:123], v63 offset:5120
    s_waitcnt lgkmcnt(7)
    v_mfma_f32_32x32x16_bf16 v[32:47], a[92:95], v[92:95], v[32:47]
    ds_read_b128 v[124:127], v63 offset:7168
    s_waitcnt lgkmcnt(7)
    v_mfma_f32_32x32x16_bf16 v[32:47], a[96:99], v[96:99], v[32:47]
    s_waitcnt lgkmcnt(6)
    v_mfma_f32_32x32x16_bf16 v[32:47], a[100:103], v[100:103], v[32:47]
    s_waitcnt lgkmcnt(5)
    v_mfma_f32_32x32x16_bf16 v[32:47], a[104:107], v[104:107], v[32:47]
    s_waitcnt lgkmcnt(4)
    v_mfma_f32_32x32x16_bf16 v[32:47], a[108:111], v[108:111], v[32:47]
    s_waitcnt lgkmcnt(3)
    v_mfma_f32_32x32x16_bf16 v[32:47], a[112:115], v[112:115], v[32:47]
    s_waitcnt lgkmcnt(2)
    v_mfma_f32_32x32x16_bf16 v[32:47], a[116:119], v[116:119], v[32:47]
    s_waitcnt lgkmcnt(1)
    v_mfma_f32_32x32x16_bf16 v[32:47], a[120:123], v[120:123], v[32:47]
    s_waitcnt lgkmcnt(0)
    v_mfma_f32_32x32x16_bf16 v[32:47], a[124:127], v[124:127], v[32:47]
    s_nop 7
    s_nop 7
    v_cvt_pk_bf16_f32 v145, v32, v33
    v_cvt_pk_bf16_f32 v146, v34, v35
    v_mov_b32 v144, s38
    v_mov_b32 v147, s39
    s_add_u32 s34, s50, 131072
    buffer_store_dwordx4 v[144:147], v13, s[20:23], s34 offen sc1
    v_cvt_pk_bf16_f32 v149, v36, v37
    v_cvt_pk_bf16_f32 v150, v38, v39
    v_mov_b32 v148, s38
    v_mov_b32 v151, s39
    s_add_u32 s34, s50, 163840
    buffer_store_dwordx4 v[148:151], v13, s[20:23], s34 offen sc1
    v_cvt_pk_bf16_f32 v153, v40, v41
    v_cvt_pk_bf16_f32 v154, v42, v43
    v_mov_b32 v152, s38
    v_mov_b32 v155, s39
    s_add_u32 s34, s50, 196608
    buffer_store_dwordx4 v[152:155], v13, s[20:23], s34 offen sc1
    v_cvt_pk_bf16_f32 v157, v44, v45
    v_cvt_pk_bf16_f32 v158, v46, v47
    v_mov_b32 v156, s38
    v_mov_b32 v159, s39
    s_add_u32 s34, s50, 229376
    buffer_store_dwordx4 v[156:159], v13, s[20:23], s34 offen sc1
    s_lshl_b32 s43, s26, 16
    s_add_u32 s16, s58, s43
    s_addc_u32 s17, s59, 0
    s_mov_b32 s18, 65536
    s_mov_b32 s19, 0x20000
    s_lshr_b32 s54, s25, 2
    s_lshl_b32 s54, s54, 15
    s_lshl_b32 s55, s27, 8
    s_add_u32 s54, s54, s55
    s_lshl_b32 s55, s24, 6
    s_add_u32 s54, s54, s55
    s_and_b32 s55, s25, 3
    s_lshl_b32 s55, s55, 4
    s_add_u32 s54, s54, s55
    v_and_b32 v3, 31, v2
    v_lshrrev_b32 v4, 5, v2
    v_lshlrev_b32 v5, 10, v3
    v_lshlrev_b32 v6, 3, v4
    v_add_u32 v5, v5, v6
    s_mov_b32 s44, 0
F_x2_full:
    s_add_u32 s34, s51, 0
    buffer_load_dwordx4 v[64:67], v13, s[20:23], s34 offen sc1
    s_add_u32 s34, s51, 4096
    buffer_load_dwordx4 v[68:71], v13, s[20:23], s34 offen sc1
    s_add_u32 s34, s51, 8192
    buffer_load_dwordx4 v[72:75], v13, s[20:23], s34 offen sc1
    s_add_u32 s34, s51, 12288
    buffer_load_dwordx4 v[76:79], v13, s[20:23], s34 offen sc1
    s_add_u32 s34, s51, 16384
    buffer_load_dwordx4 v[80:83], v13, s[20:23], s34 offen sc1
    s_add_u32 s34, s51, 20480
    buffer_load_dwordx4 v[84:87], v13, s[20:23], s34 offen sc1
    s_add_u32 s34, s51, 24576
    buffer_load_dwordx4 v[88:91], v13, s[20:23], s34 offen sc1
    s_add_u32 s34, s51, 28672
    buffer_load_dwordx4 v[92:95], v13, s[20:23], s34 offen sc1
    s_waitcnt vmcnt(0)
    s_mov_b64 s[48:49], -1
    v_cmp_eq_u32 vcc, s38, v64
    v_cmp_eq_u32 s[46:47], s39, v67
    s_nop 1
    s_and_b64 s[48:49], s[48:49], vcc
    s_and_b64 s[48:49], s[48:49], s[46:47]
    v_cmp_eq_u32 vcc, s38, v68
    v_cmp_eq_u32 s[46:47], s39, v71
    s_nop 1
    s_and_b64 s[48:49], s[48:49], vcc
    s_and_b64 s[48:49], s[48:49], s[46:47]
    v_cmp_eq_u32 vcc, s38, v72
    v_cmp_eq_u32 s[46:47], s39, v75
    s_nop 1
    s_and_b64 s[48:49], s[48:49], vcc
    s_and_b64 s[48:49], s[48:49], s[46:47]
    v_cmp_eq_u32 vcc, s38, v76
    v_cmp_eq_u32 s[46:47], s39, v79
    s_nop 1
    s_and_b64 s[48:49], s[48:49], vcc
    s_and_b64 s[48:49], s[48:49], s[46:47]
    v_cmp_eq_u32 vcc, s38, v80
    v_cmp_eq_u32 s[46:47], s39, v83
    s_nop 1
    s_and_b64 s[48:49], s[48:49], vcc
    s_and_b64 s[48:49], s[48:49], s[46:47]
    v_cmp_eq_u32 vcc, s38, v84
    v_cmp_eq_u32 s[46:47], s39, v87
    s_nop 1
    s_and_b64 s[48:49], s[48:49], vcc
    s_and_b64 s[48:49], s[48:49], s[46:47]
    v_cmp_eq_u32 vcc, s38, v88
    v_cmp_eq_u32 s[46:47], s39, v91
    s_nop 1
    s_and_b64 s[48:49], s[48:49], vcc
    s_and_b64 s[48:49], s[48:49], s[46:47]
    v_cmp_eq_u32 vcc, s38, v92
    v_cmp_eq_u32 s[46:47], s39, v95
    s_nop 1
    s_and_b64 s[48:49], s[48:49], vcc
    s_and_b64 s[48:49], s[48:49], s[46:47]
    s_cmp_eq_u64 s[48:49], -1
    s_cbranch_scc1 F_x2_ok
    s_add_u32 s44, s44, 1
    s_cmp_lt_u32 s44, 300000
    s_cbranch_scc1 F_x2_full
F_x2_ok:
    v_lshlrev_b32 v96, 16, v65
    v_and_b32 v97, 0xffff0000, v65
    v_lshlrev_b32 v98, 16, v66
    v_and_b32 v99, 0xffff0000, v66
    v_lshlrev_b32 v100, 16, v69
    v_and_b32 v101, 0xffff0000, v69
    v_add_f32 v96, v96, v100
    v_add_f32 v97, v97, v101
    v_lshlrev_b32 v100, 16, v70
    v_and_b32 v101, 0xffff0000, v70
    v_add_f32 v98, v98, v100
    v_add_f32 v99, v99, v101
    v_lshlrev_b32 v100, 16, v73
    v_and_b32 v101, 0xffff0000, v73
    v_add_f32 v96, v96, v100
    v_add_f32 v97, v97, v101
    v_lshlrev_b32 v100, 16, v74
    v_and_b32 v101, 0xffff0000, v74
    v_add_f32 v98, v98, v100
    v_add_f32 v99, v99, v101
    v_lshlrev_b32 v100, 16, v77
    v_and_b32 v101, 0xffff0000, v77
    v_add_f32 v96, v96, v100
    v_add_f32 v97, v97, v101
    v_lshlrev_b32 v100, 16, v78
    v_and_b32 v101, 0xffff0000, v78
    v_add_f32 v98, v98, v100
    v_add_f32 v99, v99, v101
    v_lshlrev_b32 v100, 16, v81
    v_and_b32 v101, 0xffff0000, v81
    v_add_f32 v96, v96, v100
    v_add_f32 v97, v97, v101
    v_lshlrev_b32 v100, 16, v82
    v_and_b32 v101, 0xffff0000, v82
    v_add_f32 v98, v98, v100
    v_add_f32 v99, v99, v101
    v_lshlrev_b32 v100, 16, v85
    v_and_b32 v101, 0xffff0000, v85
    v_add_f32 v96, v96, v100
    v_add_f32 v97, v97, v101
    v_lshlrev_b32 v100, 16, v86
    v_and_b32 v101, 0xffff0000, v86
    v_add_f32 v98, v98, v100
    v_add_f32 v99, v99, v101
    v_lshlrev_b32 v100, 16, v89
    v_and_b32 v101, 0xffff0000, v89
    v_add_f32 v96, v96, v100
    v_add_f32 v97, v97, v101
    v_lshlrev_b32 v100, 16, v90
    v_and_b32 v101, 0xffff0000, v90
    v_add_f32 v98, v98, v100
    v_add_f32 v99, v99, v101
    v_lshlrev_b32 v100, 16, v93
    v_and_b32 v101, 0xffff0000, v93
    v_add_f32 v96, v96, v100
    v_add_f32 v97, v97, v101
    v_lshlrev_b32 v100, 16, v94
    v_and_b32 v101, 0xffff0000, v94
    v_add_f32 v98, v98, v100
    v_add_f32 v99, v99, v101
    v_cvt_pk_bf16_f32 v102, v96, v97
    v_cvt_pk_bf16_f32 v103, v98, v99
    buffer_store_dwordx2 v[102:103], v5, s[16:19], s54 offen
    s_waitcnt vmcnt(0)
    s_branch F_end
F_stub0:
    s_call_b64 s[62:63], F_rare0
    s_branch F_back0
F_stub1:
    s_call_b64 s[62:63], F_rare1
    s_branch F_back1
F_stub2:
    s_call_b64 s[62:63], F_rare0
    s_branch F_back2
F_stub3:
    s_call_b64 s[62:63], F_rare1
    s_branch F_back3
F_stub4:
    s_call_b64 s[62:63], F_rare0
    s_branch F_back4
F_stub5:
    s_call_b64 s[62:63], F_rare1
    s_branch F_back5
F_stub6:
    s_call_b64 s[62:63], F_rare0
    s_branch F_back6
F_stub7:
    s_call_b64 s[62:63], F_rare1
    s_branch F_back7
F_stub8:
    s_call_b64 s[62:63], F_rare0
    s_branch F_back8
F_stub9:
    s_call_b64 s[62:63], F_rare1
    s_branch F_back9
F_stub10:
    s_call_b64 s[62:63], F_rare0
    s_branch F_back10
F_stub11:
    s_call_b64 s[62:63], F_rare1
    s_branch F_back11
F_stub12:
    s_call_b64 s[62:63], F_rare0
    s_branch F_back12
F_stub13:
    s_call_b64 s[62:63], F_rare1
    s_branch F_back13
F_stub14:
    s_call_b64 s[62:63], F_rare0
    s_branch F_back14
F_stub15:
    s_call_b64 s[62:63], F_rare1
    s_branch F_back15
F_rare0:
    s_nop 15
    s_nop 15
    v_max3_f32 v54, v64, v65, v66
    v_max3_f32 v54, v54, v67, v68
    v_max3_f32 v54, v54, v69, v70
    v_max3_f32 v54, v54, v71, v72
    v_max3_f32 v54, v54, v73, v74
    v_max3_f32 v54, v54, v75, v76
    v_max3_f32 v54, v54, v77, v78
    v_max_f32 v54, v54, v79
    v_mov_b32 v55, v54
    s_nop 1
    v_permlane32_swap_b32 v54, v55
    s_nop 1
    v_max3_f32 v54, v54, v55, 0
    v_sub_f32 v55, 0, v54
    v_exp_f32 v55, v55
    v_sub_f32 v160, v160, v54
    v_sub_f32 v64, v64, v54
    v_sub_f32 v96, v96, v54
    v_sub_f32 v161, v161, v54
    v_sub_f32 v65, v65, v54
    v_sub_f32 v97, v97, v54
    v_sub_f32 v162, v162, v54
    v_sub_f32 v66, v66, v54
    v_sub_f32 v98, v98, v54
    v_sub_f32 v163, v163, v54
    v_sub_f32 v67, v67, v54
    v_sub_f32 v99, v99, v54
    v_sub_f32 v164, v164, v54
    v_sub_f32 v68, v68, v54
    v_sub_f32 v100, v100, v54
    v_sub_f32 v165, v165, v54
    v_sub_f32 v69, v69, v54
    v_sub_f32 v101, v101, v54
    v_sub_f32 v166, v166, v54
    v_sub_f32 v70, v70, v54
    v_sub_f32 v102, v102, v54
    v_sub_f32 v167, v167, v54
    v_sub_f32 v71, v71, v54
    v_sub_f32 v103, v103, v54
    v_sub_f32 v168, v168, v54
    v_sub_f32 v72, v72, v54
    v_sub_f32 v104, v104, v54
    v_sub_f32 v169, v169, v54
    v_sub_f32 v73, v73, v54
    v_sub_f32 v105, v105, v54
    v_sub_f32 v170, v170, v54
    v_sub_f32 v74, v74, v54
    v_sub_f32 v106, v106, v54
    v_sub_f32 v171, v171, v54
    v_sub_f32 v75, v75, v54
    v_sub_f32 v107, v107, v54
    v_sub_f32 v172, v172, v54
    v_sub_f32 v76, v76, v54
    v_sub_f32 v108, v108, v54
    v_sub_f32 v173, v173, v54
    v_sub_f32 v77, v77, v54
    v_sub_f32 v109, v109, v54
    v_sub_f32 v174, v174, v54
    v_sub_f32 v78, v78, v54
    v_sub_f32 v110, v110, v54
    v_sub_f32 v175, v175, v54
    v_sub_f32 v79, v79, v54
    v_sub_f32 v111, v111, v54
    v_mul_f32 v52, v52, v55
    v_accvgpr_read_b32 v56, a0
    v_mul_f32 v56, v56, v55
    v_accvgpr_write_b32 a0, v56
    v_accvgpr_read_b32 v56, a1
    v_mul_f32 v56, v56, v55
    v_accvgpr_write_b32 a1, v56
    v_accvgpr_read_b32 v56, a2
    v_mul_f32 v56, v56, v55
    v_accvgpr_write_b32 a2, v56
    v_accvgpr_read_b32 v56, a3
    v_mul_f32 v56, v56, v55
    v_accvgpr_write_b32 a3, v56
    v_accvgpr_read_b32 v56, a4
    v_mul_f32 v56, v56, v55
    v_accvgpr_write_b32 a4, v56
    v_accvgpr_read_b32 v56, a5
    v_mul_f32 v56, v56, v55
    v_accvgpr_write_b32 a5, v56
    v_accvgpr_read_b32 v56, a6
    v_mul_f32 v56, v56, v55
    v_accvgpr_write_b32 a6, v56
    v_accvgpr_read_b32 v56, a7
    v_mul_f32 v56, v56, v55
    v_accvgpr_write_b32 a7, v56
    v_accvgpr_read_b32 v56, a8
    v_mul_f32 v56, v56, v55
    v_accvgpr_write_b32 a8, v56
    v_accvgpr_read_b32 v56, a9
    v_mul_f32 v56, v56, v55
    v_accvgpr_write_b32 a9, v56
    v_accvgpr_read_b32 v56, a10
    v_mul_f32 v56, v56, v55
    v_accvgpr_write_b32 a10, v56
    v_accvgpr_read_b32 v56, a11
    v_mul_f32 v56, v56, v55
    v_accvgpr_write_b32 a11, v56
    v_accvgpr_read_b32 v56, a12
    v_mul_f32 v56, v56, v55
    v_accvgpr_write_b32 a12, v56
    v_accvgpr_read_b32 v56, a13
    v_mul_f32 v56, v56, v55
    v_accvgpr_write_b32 a13, v56
    v_accvgpr_read_b32 v56, a14
    v_mul_f32 v56, v56, v55
    v_accvgpr_write_b32 a14, v56
    v_accvgpr_read_b32 v56, a15
    v_mul_f32 v56, v56, v55
    v_accvgpr_write_b32 a15, v56
    v_accvgpr_read_b32 v56, a32
    v_mul_f32 v56, v56, v55
    v_accvgpr_write_b32 a32, v56
    v_accvgpr_read_b32 v56, a33
    v_mul_f32 v56, v56, v55
    v_accvgpr_write_b32 a33, v56
    v_accvgpr_read_b32 v56, a34
    v_mul_f32 v56, v56, v55
    v_accvgpr_write_b32 a34, v56
    v_accvgpr_read_b32 v56, a35
    v_mul_f32 v56, v56, v55
    v_accvgpr_write_b32 a35, v56
    v_accvgpr_read_b32 v56, a36
    v_mul_f32 v56, v56, v55
    v_accvgpr_write_b32 a36, v56
    v_accvgpr_read_b32 v56, a37
    v_mul_f32 v56, v56, v55
    v_accvgpr_write_b32 a37, v56
    v_accvgpr_read_b32 v56, a38
    v_mul_f32 v56, v56, v55
    v_accvgpr_write_b32 a38, v56
    v_accvgpr_read_b32 v56, a39
    v_mul_f32 v56, v56, v55
    v_accvgpr_write_b32 a39, v56
    v_accvgpr_read_b32 v56, a40
    v_mul_f32 v56, v56, v55
    v_accvgpr_write_b32 a40, v56
    v_accvgpr_read_b32 v56, a41
    v_mul_f32 v56, v56, v55
    v_accvgpr_write_b32 a41, v56
    v_accvgpr_read_b32 v56, a42
    v_mul_f32 v56, v56, v55
    v_accvgpr_write_b32 a42, v56
    v_accvgpr_read_b32 v56, a43
    v_mul_f32 v56, v56, v55
    v_accvgpr_write_b32 a43, v56
    v_accvgpr_read_b32 v56, a44
    v_mul_f32 v56, v56, v55
    v_accvgpr_write_b32 a44, v56
    v_accvgpr_read_b32 v56, a45
    v_mul_f32 v56, v56, v55
    v_accvgpr_write_b32 a45, v56
    v_accvgpr_read_b32 v56, a46
    v_mul_f32 v56, v56, v55
    v_accvgpr_write_b32 a46, v56
    v_accvgpr_read_b32 v56, a47
    v_mul_f32 v56, v56, v55
    v_accvgpr_write_b32 a47, v56
    v_accvgpr_read_b32 v56, a64
    v_mul_f32 v56, v56, v55
    v_accvgpr_write_b32 a64, v56
    v_accvgpr_read_b32 v56, a65
    v_mul_f32 v56, v56, v55
    v_accvgpr_write_b32 a65, v56
    v_accvgpr_read_b32 v56, a66
    v_mul_f32 v56, v56, v55
    v_accvgpr_write_b32 a66, v56
    v_accvgpr_read_b32 v56, a67
    v_mul_f32 v56, v56, v55
    v_accvgpr_write_b32 a67, v56
    v_accvgpr_read_b32 v56, a68
    v_mul_f32 v56, v56, v55
    v_accvgpr_write_b32 a68, v56
    v_accvgpr_read_b32 v56, a69
    v_mul_f32 v56, v56, v55
    v_accvgpr_write_b32 a69, v56
    v_accvgpr_read_b32 v56, a70
    v_mul_f32 v56, v56, v55
    v_accvgpr_write_b32 a70, v56
    v_accvgpr_read_b32 v56, a71
    v_mul_f32 v56, v56, v55
    v_accvgpr_write_b32 a71, v56
    v_accvgpr_read_b32 v56, a72
    v_mul_f32 v56, v56, v55
    v_accvgpr_write_b32 a72, v56
    v_accvgpr_read_b32 v56, a73
    v_mul_f32 v56, v56, v55
    v_accvgpr_write_b32 a73, v56
    v_accvgpr_read_b32 v56, a74
    v_mul_f32 v56, v56, v55
    v_accvgpr_write_b32 a74, v56
    v_accvgpr_read_b32 v56, a75
    v_mul_f32 v56, v56, v55
    v_accvgpr_write_b32 a75, v56
    v_accvgpr_read_b32 v56, a76
    v_mul_f32 v56, v56, v55
    v_accvgpr_write_b32 a76, v56
    v_accvgpr_read_b32 v56, a77
    v_mul_f32 v56, v56, v55
    v_accvgpr_write_b32 a77, v56
    v_accvgpr_read_b32 v56, a78
    v_mul_f32 v56, v56, v55
    v_accvgpr_write_b32 a78, v56
    v_accvgpr_read_b32 v56, a79
    v_mul_f32 v56, v56, v55
    v_accvgpr_write_b32 a79, v56
    v_accvgpr_read_b32 v56, a96
    v_mul_f32 v56, v56, v55
    v_accvgpr_write_b32 a96, v56
    v_accvgpr_read_b32 v56, a97
    v_mul_f32 v56, v56, v55
    v_accvgpr_write_b32 a97, v56
    v_accvgpr_read_b32 v56, a98
    v_mul_f32 v56, v56, v55
    v_accvgpr_write_b32 a98, v56
    v_accvgpr_read_b32 v56, a99
    v_mul_f32 v56, v56, v55
    v_accvgpr_write_b32 a99, v56
    v_accvgpr_read_b32 v56, a100
    v_mul_f32 v56, v56, v55
    v_accvgpr_write_b32 a100, v56
    v_accvgpr_read_b32 v56, a101
    v_mul_f32 v56, v56, v55
    v_accvgpr_write_b32 a101, v56
    v_accvgpr_read_b32 v56, a102
    v_mul_f32 v56, v56, v55
    v_accvgpr_write_b32 a102, v56
    v_accvgpr_read_b32 v56, a103
    v_mul_f32 v56, v56, v55
    v_accvgpr_write_b32 a103, v56
    v_accvgpr_read_b32 v56, a104
    v_mul_f32 v56, v56, v55
    v_accvgpr_write_b32 a104, v56
    v_accvgpr_read_b32 v56, a105
    v_mul_f32 v56, v56, v55
    v_accvgpr_write_b32 a105, v56
    v_accvgpr_read_b32 v56, a106
    v_mul_f32 v56, v56, v55
    v_accvgpr_write_b32 a106, v56
    v_accvgpr_read_b32 v56, a107
    v_mul_f32 v56, v56, v55
    v_accvgpr_write_b32 a107, v56
    v_accvgpr_read_b32 v56, a108
    v_mul_f32 v56, v56, v55
    v_accvgpr_write_b32 a108, v56
    v_accvgpr_read_b32 v56, a109
    v_mul_f32 v56, v56, v55
    v_accvgpr_write_b32 a109, v56
    v_accvgpr_read_b32 v56, a110
    v_mul_f32 v56, v56, v55
    v_accvgpr_write_b32 a110, v56
    v_accvgpr_read_b32 v56, a111
    v_mul_f32 v56, v56, v55
    v_accvgpr_write_b32 a111, v56
    v_exp_f32 v216, v64
    v_exp_f32 v217, v65
    v_exp_f32 v218, v66
    v_exp_f32 v219, v67
    v_exp_f32 v220, v68
    v_exp_f32 v221, v69
    v_exp_f32 v222, v70
    v_exp_f32 v223, v71
    v_exp_f32 v224, v72
    v_exp_f32 v225, v73
    v_exp_f32 v226, v74
    v_exp_f32 v227, v75
    v_exp_f32 v228, v76
    v_exp_f32 v229, v77
    v_exp_f32 v230, v78
    v_exp_f32 v231, v79
    s_nop 0
    v_add_f32 v48, v216, v217
    v_add_f32 v48, v48, v218
    v_add_f32 v48, v48, v219
    v_add_f32 v48, v48, v220
    v_add_f32 v48, v48, v221
    v_add_f32 v48, v48, v222
    v_add_f32 v48, v48, v223
    v_add_f32 v48, v48, v224
    v_add_f32 v48, v48, v225
    v_add_f32 v48, v48, v226
    v_add_f32 v48, v48, v227
    v_add_f32 v48, v48, v228
    v_add_f32 v48, v48, v229
    v_add_f32 v48, v48, v230
    v_add_f32 v48, v48, v231
    v_cvt_pk_bf16_f32 v128, v216, v217
    v_cvt_pk_bf16_f32 v129, v218, v219
    v_cvt_pk_bf16_f32 v130, v220, v221
    v_cvt_pk_bf16_f32 v131, v222, v223
    v_cvt_pk_bf16_f32 v132, v224, v225
    v_cvt_pk_bf16_f32 v133, v226, v227
    v_cvt_pk_bf16_f32 v134, v228, v229
    v_cvt_pk_bf16_f32 v135, v230, v231
    v_max3_f32 v54, v80, v81, v82
    v_max3_f32 v54, v54, v83, v84
    v_max3_f32 v54, v54, v85, v86
    v_max3_f32 v54, v54, v87, v88
    v_max3_f32 v54, v54, v89, v90
    v_max3_f32 v54, v54, v91, v92
    v_max3_f32 v54, v54, v93, v94
    v_max_f32 v54, v54, v95
    v_mov_b32 v55, v54
    s_nop 1
    v_permlane32_swap_b32 v54, v55
    s_nop 1
    v_max3_f32 v54, v54, v55, 0
    v_sub_f32 v55, 0, v54
    v_exp_f32 v55, v55
    v_sub_f32 v176, v176, v54
    v_sub_f32 v80, v80, v54
    v_sub_f32 v112, v112, v54
    v_sub_f32 v177, v177, v54
    v_sub_f32 v81, v81, v54
    v_sub_f32 v113, v113, v54
    v_sub_f32 v178, v178, v54
    v_sub_f32 v82, v82, v54
    v_sub_f32 v114, v114, v54
    v_sub_f32 v179, v179, v54
    v_sub_f32 v83, v83, v54
    v_sub_f32 v115, v115, v54
    v_sub_f32 v180, v180, v54
    v_sub_f32 v84, v84, v54
    v_sub_f32 v116, v116, v54
    v_sub_f32 v181, v181, v54
    v_sub_f32 v85, v85, v54
    v_sub_f32 v117, v117, v54
    v_sub_f32 v182, v182, v54
    v_sub_f32 v86, v86, v54
    v_sub_f32 v118, v118, v54
    v_sub_f32 v183, v183, v54
    v_sub_f32 v87, v87, v54
    v_sub_f32 v119, v119, v54
    v_sub_f32 v184, v184, v54
    v_sub_f32 v88, v88, v54
    v_sub_f32 v120, v120, v54
    v_sub_f32 v185, v185, v54
    v_sub_f32 v89, v89, v54
    v_sub_f32 v121, v121, v54
    v_sub_f32 v186, v186, v54
    v_sub_f32 v90, v90, v54
    v_sub_f32 v122, v122, v54
    v_sub_f32 v187, v187, v54
    v_sub_f32 v91, v91, v54
    v_sub_f32 v123, v123, v54
    v_sub_f32 v188, v188, v54
    v_sub_f32 v92, v92, v54
    v_sub_f32 v124, v124, v54
    v_sub_f32 v189, v189, v54
    v_sub_f32 v93, v93, v54
    v_sub_f32 v125, v125, v54
    v_sub_f32 v190, v190, v54
    v_sub_f32 v94, v94, v54
    v_sub_f32 v126, v126, v54
    v_sub_f32 v191, v191, v54
    v_sub_f32 v95, v95, v54
    v_sub_f32 v127, v127, v54
    v_mul_f32 v53, v53, v55
    v_accvgpr_read_b32 v56, a16
    v_mul_f32 v56, v56, v55
    v_accvgpr_write_b32 a16, v56
    v_accvgpr_read_b32 v56, a17
    v_mul_f32 v56, v56, v55
    v_accvgpr_write_b32 a17, v56
    v_accvgpr_read_b32 v56, a18
    v_mul_f32 v56, v56, v55
    v_accvgpr_write_b32 a18, v56
    v_accvgpr_read_b32 v56, a19
    v_mul_f32 v56, v56, v55
    v_accvgpr_write_b32 a19, v56
    v_accvgpr_read_b32 v56, a20
    v_mul_f32 v56, v56, v55
    v_accvgpr_write_b32 a20, v56
    v_accvgpr_read_b32 v56, a21
    v_mul_f32 v56, v56, v55
    v_accvgpr_write_b32 a21, v56
    v_accvgpr_read_b32 v56, a22
    v_mul_f32 v56, v56, v55
    v_accvgpr_write_b32 a22, v56
    v_accvgpr_read_b32 v56, a23
    v_mul_f32 v56, v56, v55
    v_accvgpr_write_b32 a23, v56
    v_accvgpr_read_b32 v56, a24
    v_mul_f32 v56, v56, v55
    v_accvgpr_write_b32 a24, v56
    v_accvgpr_read_b32 v56, a25
    v_mul_f32 v56, v56, v55
    v_accvgpr_write_b32 a25, v56
    v_accvgpr_read_b32 v56, a26
    v_mul_f32 v56, v56, v55
    v_accvgpr_write_b32 a26, v56
    v_accvgpr_read_b32 v56, a27
    v_mul_f32 v56, v56, v55
    v_accvgpr_write_b32 a27, v56
    v_accvgpr_read_b32 v56, a28
    v_mul_f32 v56, v56, v55
    v_accvgpr_write_b32 a28, v56
    v_accvgpr_read_b32 v56, a29
    v_mul_f32 v56, v56, v55
    v_accvgpr_write_b32 a29, v56
    v_accvgpr_read_b32 v56, a30
    v_mul_f32 v56, v56, v55
    v_accvgpr_write_b32 a30, v56
    v_accvgpr_read_b32 v56, a31
    v_mul_f32 v56, v56, v55
    v_accvgpr_write_b32 a31, v56
    v_accvgpr_read_b32 v56, a48
    v_mul_f32 v56, v56, v55
    v_accvgpr_write_b32 a48, v56
    v_accvgpr_read_b32 v56, a49
    v_mul_f32 v56, v56, v55
    v_accvgpr_write_b32 a49, v56
    v_accvgpr_read_b32 v56, a50
    v_mul_f32 v56, v56, v55
    v_accvgpr_write_b32 a50, v56
    v_accvgpr_read_b32 v56, a51
    v_mul_f32 v56, v56, v55
    v_accvgpr_write_b32 a51, v56
    v_accvgpr_read_b32 v56, a52
    v_mul_f32 v56, v56, v55
    v_accvgpr_write_b32 a52, v56
    v_accvgpr_read_b32 v56, a53
    v_mul_f32 v56, v56, v55
    v_accvgpr_write_b32 a53, v56
    v_accvgpr_read_b32 v56, a54
    v_mul_f32 v56, v56, v55
    v_accvgpr_write_b32 a54, v56
    v_accvgpr_read_b32 v56, a55
    v_mul_f32 v56, v56, v55
    v_accvgpr_write_b32 a55, v56
    v_accvgpr_read_b32 v56, a56
    v_mul_f32 v56, v56, v55
    v_accvgpr_write_b32 a56, v56
    v_accvgpr_read_b32 v56, a57
    v_mul_f32 v56, v56, v55
    v_accvgpr_write_b32 a57, v56
    v_accvgpr_read_b32 v56, a58
    v_mul_f32 v56, v56, v55
    v_accvgpr_write_b32 a58, v56
    v_accvgpr_read_b32 v56, a59
    v_mul_f32 v56, v56, v55
    v_accvgpr_write_b32 a59, v56
    v_accvgpr_read_b32 v56, a60
    v_mul_f32 v56, v56, v55
    v_accvgpr_write_b32 a60, v56
    v_accvgpr_read_b32 v56, a61
    v_mul_f32 v56, v56, v55
    v_accvgpr_write_b32 a61, v56
    v_accvgpr_read_b32 v56, a62
    v_mul_f32 v56, v56, v55
    v_accvgpr_write_b32 a62, v56
    v_accvgpr_read_b32 v56, a63
    v_mul_f32 v56, v56, v55
    v_accvgpr_write_b32 a63, v56
    v_accvgpr_read_b32 v56, a80
    v_mul_f32 v56, v56, v55
    v_accvgpr_write_b32 a80, v56
    v_accvgpr_read_b32 v56, a81
    v_mul_f32 v56, v56, v55
    v_accvgpr_write_b32 a81, v56
    v_accvgpr_read_b32 v56, a82
    v_mul_f32 v56, v56, v55
    v_accvgpr_write_b32 a82, v56
    v_accvgpr_read_b32 v56, a83
    v_mul_f32 v56, v56, v55
    v_accvgpr_write_b32 a83, v56
    v_accvgpr_read_b32 v56, a84
    v_mul_f32 v56, v56, v55
    v_accvgpr_write_b32 a84, v56
    v_accvgpr_read_b32 v56, a85
    v_mul_f32 v56, v56, v55
    v_accvgpr_write_b32 a85, v56
    v_accvgpr_read_b32 v56, a86
    v_mul_f32 v56, v56, v55
    v_accvgpr_write_b32 a86, v56
    v_accvgpr_read_b32 v56, a87
    v_mul_f32 v56, v56, v55
    v_accvgpr_write_b32 a87, v56
    v_accvgpr_read_b32 v56, a88
    v_mul_f32 v56, v56, v55
    v_accvgpr_write_b32 a88, v56
    v_accvgpr_read_b32 v56, a89
    v_mul_f32 v56, v56, v55
    v_accvgpr_write_b32 a89, v56
    v_accvgpr_read_b32 v56, a90
    v_mul_f32 v56, v56, v55
    v_accvgpr_write_b32 a90, v56
    v_accvgpr_read_b32 v56, a91
    v_mul_f32 v56, v56, v55
    v_accvgpr_write_b32 a91, v56
    v_accvgpr_read_b32 v56, a92
    v_mul_f32 v56, v56, v55
    v_accvgpr_write_b32 a92, v56
    v_accvgpr_read_b32 v56, a93
    v_mul_f32 v56, v56, v55
    v_accvgpr_write_b32 a93, v56
    v_accvgpr_read_b32 v56, a94
    v_mul_f32 v56, v56, v55
    v_accvgpr_write_b32 a94, v56
    v_accvgpr_read_b32 v56, a95
    v_mul_f32 v56, v56, v55
    v_accvgpr_write_b32 a95, v56
    v_accvgpr_read_b32 v56, a112
    v_mul_f32 v56, v56, v55
    v_accvgpr_write_b32 a112, v56
    v_accvgpr_read_b32 v56, a113
    v_mul_f32 v56, v56, v55
    v_accvgpr_write_b32 a113, v56
    v_accvgpr_read_b32 v56, a114
    v_mul_f32 v56, v56, v55
    v_accvgpr_write_b32 a114, v56
    v_accvgpr_read_b32 v56, a115
    v_mul_f32 v56, v56, v55
    v_accvgpr_write_b32 a115, v56
    v_accvgpr_read_b32 v56, a116
    v_mul_f32 v56, v56, v55
    v_accvgpr_write_b32 a116, v56
    v_accvgpr_read_b32 v56, a117
    v_mul_f32 v56, v56, v55
    v_accvgpr_write_b32 a117, v56
    v_accvgpr_read_b32 v56, a118
    v_mul_f32 v56, v56, v55
    v_accvgpr_write_b32 a118, v56
    v_accvgpr_read_b32 v56, a119
    v_mul_f32 v56, v56, v55
    v_accvgpr_write_b32 a119, v56
    v_accvgpr_read_b32 v56, a120
    v_mul_f32 v56, v56, v55
    v_accvgpr_write_b32 a120, v56
    v_accvgpr_read_b32 v56, a121
    v_mul_f32 v56, v56, v55
    v_accvgpr_write_b32 a121, v56
    v_accvgpr_read_b32 v56, a122
    v_mul_f32 v56, v56, v55
    v_accvgpr_write_b32 a122, v56
    v_accvgpr_read_b32 v56, a123
    v_mul_f32 v56, v56, v55
    v_accvgpr_write_b32 a123, v56
    v_accvgpr_read_b32 v56, a124
    v_mul_f32 v56, v56, v55
    v_accvgpr_write_b32 a124, v56
    v_accvgpr_read_b32 v56, a125
    v_mul_f32 v56, v56, v55
    v_accvgpr_write_b32 a125, v56
    v_accvgpr_read_b32 v56, a126
    v_mul_f32 v56, v56, v55
    v_accvgpr_write_b32 a126, v56
    v_accvgpr_read_b32 v56, a127
    v_mul_f32 v56, v56, v55
    v_accvgpr_write_b32 a127, v56
    v_exp_f32 v216, v80
    v_exp_f32 v217, v81
    v_exp_f32 v218, v82
    v_exp_f32 v219, v83
    v_exp_f32 v220, v84
    v_exp_f32 v221, v85
    v_exp_f32 v222, v86
    v_exp_f32 v223, v87
    v_exp_f32 v224, v88
    v_exp_f32 v225, v89
    v_exp_f32 v226, v90
    v_exp_f32 v227, v91
    v_exp_f32 v228, v92
    v_exp_f32 v229, v93
    v_exp_f32 v230, v94
    v_exp_f32 v231, v95
    s_nop 0
    v_add_f32 v49, v216, v217
    v_add_f32 v49, v49, v218
    v_add_f32 v49, v49, v219
    v_add_f32 v49, v49, v220
    v_add_f32 v49, v49, v221
    v_add_f32 v49, v49, v222
    v_add_f32 v49, v49, v223
    v_add_f32 v49, v49, v224
    v_add_f32 v49, v49, v225
    v_add_f32 v49, v49, v226
    v_add_f32 v49, v49, v227
    v_add_f32 v49, v49, v228
    v_add_f32 v49, v49, v229
    v_add_f32 v49, v49, v230
    v_add_f32 v49, v49, v231
    v_cvt_pk_bf16_f32 v136, v216, v217
    v_cvt_pk_bf16_f32 v137, v218, v219
    v_cvt_pk_bf16_f32 v138, v220, v221
    v_cvt_pk_bf16_f32 v139, v222, v223
    v_cvt_pk_bf16_f32 v140, v224, v225
    v_cvt_pk_bf16_f32 v141, v226, v227
    v_cvt_pk_bf16_f32 v142, v228, v229
    v_cvt_pk_bf16_f32 v143, v230, v231
    s_nop 7
    s_setpc_b64 s[62:63]
F_rare1:
    s_nop 15
    s_nop 15
    v_max3_f32 v54, v96, v97, v98
    v_max3_f32 v54, v54, v99, v100
    v_max3_f32 v54, v54, v101, v102
    v_max3_f32 v54, v54, v103, v104
    v_max3_f32 v54, v54, v105, v106
    v_max3_f32 v54, v54, v107, v108
    v_max3_f32 v54, v54, v109, v110
    v_max_f32 v54, v54, v111
    v_mov_b32 v55, v54
    s_nop 1
    v_permlane32_swap_b32 v54, v55
    s_nop 1
    v_max3_f32 v54, v54, v55, 0
    v_sub_f32 v55, 0, v54
    v_exp_f32 v55, v55
    v_sub_f32 v160, v160, v54
    v_sub_f32 v96, v96, v54
    v_sub_f32 v64, v64, v54
    v_sub_f32 v161, v161, v54
    v_sub_f32 v97, v97, v54
    v_sub_f32 v65, v65, v54
    v_sub_f32 v162, v162, v54
    v_sub_f32 v98, v98, v54
    v_sub_f32 v66, v66, v54
    v_sub_f32 v163, v163, v54
    v_sub_f32 v99, v99, v54
    v_sub_f32 v67, v67, v54
    v_sub_f32 v164, v164, v54
    v_sub_f32 v100, v100, v54
    v_sub_f32 v68, v68, v54
    v_sub_f32 v165, v165, v54
    v_sub_f32 v101, v101, v54
    v_sub_f32 v69, v69, v54
    v_sub_f32 v166, v166, v54
    v_sub_f32 v102, v102, v54
    v_sub_f32 v70, v70, v54
    v_sub_f32 v167, v167, v54
    v_sub_f32 v103, v103, v54
    v_sub_f32 v71, v71, v54
    v_sub_f32 v168, v168, v54
    v_sub_f32 v104, v104, v54
    v_sub_f32 v72, v72, v54
    v_sub_f32 v169, v169, v54
    v_sub_f32 v105, v105, v54
    v_sub_f32 v73, v73, v54
    v_sub_f32 v170, v170, v54
    v_sub_f32 v106, v106, v54
    v_sub_f32 v74, v74, v54
    v_sub_f32 v171, v171, v54
    v_sub_f32 v107, v107, v54
    v_sub_f32 v75, v75, v54
    v_sub_f32 v172, v172, v54
    v_sub_f32 v108, v108, v54
    v_sub_f32 v76, v76, v54
    v_sub_f32 v173, v173, v54
    v_sub_f32 v109, v109, v54
    v_sub_f32 v77, v77, v54
    v_sub_f32 v174, v174, v54
    v_sub_f32 v110, v110, v54
    v_sub_f32 v78, v78, v54
    v_sub_f32 v175, v175, v54
    v_sub_f32 v111, v111, v54
    v_sub_f32 v79, v79, v54
    v_mul_f32 v52, v52, v55
    v_accvgpr_read_b32 v56, a0
    v_mul_f32 v56, v56, v55
    v_accvgpr_write_b32 a0, v56
    v_accvgpr_read_b32 v56, a1
    v_mul_f32 v56, v56, v55
    v_accvgpr_write_b32 a1, v56
    v_accvgpr_read_b32 v56, a2
    v_mul_f32 v56, v56, v55
    v_accvgpr_write_b32 a2, v56
    v_accvgpr_read_b32 v56, a3
    v_mul_f32 v56, v56, v55
    v_accvgpr_write_b32 a3, v56
    v_accvgpr_read_b32 v56, a4
    v_mul_f32 v56, v56, v55
    v_accvgpr_write_b32 a4, v56
    v_accvgpr_read_b32 v56, a5
    v_mul_f32 v56, v56, v55
    v_accvgpr_write_b32 a5, v56
    v_accvgpr_read_b32 v56, a6
    v_mul_f32 v56, v56, v55
    v_accvgpr_write_b32 a6, v56
    v_accvgpr_read_b32 v56, a7
    v_mul_f32 v56, v56, v55
    v_accvgpr_write_b32 a7, v56
    v_accvgpr_read_b32 v56, a8
    v_mul_f32 v56, v56, v55
    v_accvgpr_write_b32 a8, v56
    v_accvgpr_read_b32 v56, a9
    v_mul_f32 v56, v56, v55
    v_accvgpr_write_b32 a9, v56
    v_accvgpr_read_b32 v56, a10
    v_mul_f32 v56, v56, v55
    v_accvgpr_write_b32 a10, v56
    v_accvgpr_read_b32 v56, a11
    v_mul_f32 v56, v56, v55
    v_accvgpr_write_b32 a11, v56
    v_accvgpr_read_b32 v56, a12
    v_mul_f32 v56, v56, v55
    v_accvgpr_write_b32 a12, v56
    v_accvgpr_read_b32 v56, a13
    v_mul_f32 v56, v56, v55
    v_accvgpr_write_b32 a13, v56
    v_accvgpr_read_b32 v56, a14
    v_mul_f32 v56, v56, v55
    v_accvgpr_write_b32 a14, v56
    v_accvgpr_read_b32 v56, a15
    v_mul_f32 v56, v56, v55
    v_accvgpr_write_b32 a15, v56
    v_accvgpr_read_b32 v56, a32
    v_mul_f32 v56, v56, v55
    v_accvgpr_write_b32 a32, v56
    v_accvgpr_read_b32 v56, a33
    v_mul_f32 v56, v56, v55
    v_accvgpr_write_b32 a33, v56
    v_accvgpr_read_b32 v56, a34
    v_mul_f32 v56, v56, v55
    v_accvgpr_write_b32 a34, v56
    v_accvgpr_read_b32 v56, a35
    v_mul_f32 v56, v56, v55
    v_accvgpr_write_b32 a35, v56
    v_accvgpr_read_b32 v56, a36
    v_mul_f32 v56, v56, v55
    v_accvgpr_write_b32 a36, v56
    v_accvgpr_read_b32 v56, a37
    v_mul_f32 v56, v56, v55
    v_accvgpr_write_b32 a37, v56
    v_accvgpr_read_b32 v56, a38
    v_mul_f32 v56, v56, v55
    v_accvgpr_write_b32 a38, v56
    v_accvgpr_read_b32 v56, a39
    v_mul_f32 v56, v56, v55
    v_accvgpr_write_b32 a39, v56
    v_accvgpr_read_b32 v56, a40
    v_mul_f32 v56, v56, v55
    v_accvgpr_write_b32 a40, v56
    v_accvgpr_read_b32 v56, a41
    v_mul_f32 v56, v56, v55
    v_accvgpr_write_b32 a41, v56
    v_accvgpr_read_b32 v56, a42
    v_mul_f32 v56, v56, v55
    v_accvgpr_write_b32 a42, v56
    v_accvgpr_read_b32 v56, a43
    v_mul_f32 v56, v56, v55
    v_accvgpr_write_b32 a43, v56
    v_accvgpr_read_b32 v56, a44
    v_mul_f32 v56, v56, v55
    v_accvgpr_write_b32 a44, v56
    v_accvgpr_read_b32 v56, a45
    v_mul_f32 v56, v56, v55
    v_accvgpr_write_b32 a45, v56
    v_accvgpr_read_b32 v56, a46
    v_mul_f32 v56, v56, v55
    v_accvgpr_write_b32 a46, v56
    v_accvgpr_read_b32 v56, a47
    v_mul_f32 v56, v56, v55
    v_accvgpr_write_b32 a47, v56
    v_accvgpr_read_b32 v56, a64
    v_mul_f32 v56, v56, v55
    v_accvgpr_write_b32 a64, v56
    v_accvgpr_read_b32 v56, a65
    v_mul_f32 v56, v56, v55
    v_accvgpr_write_b32 a65, v56
    v_accvgpr_read_b32 v56, a66
    v_mul_f32 v56, v56, v55
    v_accvgpr_write_b32 a66, v56
    v_accvgpr_read_b32 v56, a67
    v_mul_f32 v56, v56, v55
    v_accvgpr_write_b32 a67, v56
    v_accvgpr_read_b32 v56, a68
    v_mul_f32 v56, v56, v55
    v_accvgpr_write_b32 a68, v56
    v_accvgpr_read_b32 v56, a69
    v_mul_f32 v56, v56, v55
    v_accvgpr_write_b32 a69, v56
    v_accvgpr_read_b32 v56, a70
    v_mul_f32 v56, v56, v55
    v_accvgpr_write_b32 a70, v56
    v_accvgpr_read_b32 v56, a71
    v_mul_f32 v56, v56, v55
    v_accvgpr_write_b32 a71, v56
    v_accvgpr_read_b32 v56, a72
    v_mul_f32 v56, v56, v55
    v_accvgpr_write_b32 a72, v56
    v_accvgpr_read_b32 v56, a73
    v_mul_f32 v56, v56, v55
    v_accvgpr_write_b32 a73, v56
    v_accvgpr_read_b32 v56, a74
    v_mul_f32 v56, v56, v55
    v_accvgpr_write_b32 a74, v56
    v_accvgpr_read_b32 v56, a75
    v_mul_f32 v56, v56, v55
    v_accvgpr_write_b32 a75, v56
    v_accvgpr_read_b32 v56, a76
    v_mul_f32 v56, v56, v55
    v_accvgpr_write_b32 a76, v56
    v_accvgpr_read_b32 v56, a77
    v_mul_f32 v56, v56, v55
    v_accvgpr_write_b32 a77, v56
    v_accvgpr_read_b32 v56, a78
    v_mul_f32 v56, v56, v55
    v_accvgpr_write_b32 a78, v56
    v_accvgpr_read_b32 v56, a79
    v_mul_f32 v56, v56, v55
    v_accvgpr_write_b32 a79, v56
    v_accvgpr_read_b32 v56, a96
    v_mul_f32 v56, v56, v55
    v_accvgpr_write_b32 a96, v56
    v_accvgpr_read_b32 v56, a97
    v_mul_f32 v56, v56, v55
    v_accvgpr_write_b32 a97, v56
    v_accvgpr_read_b32 v56, a98
    v_mul_f32 v56, v56, v55
    v_accvgpr_write_b32 a98, v56
    v_accvgpr_read_b32 v56, a99
    v_mul_f32 v56, v56, v55
    v_accvgpr_write_b32 a99, v56
    v_accvgpr_read_b32 v56, a100
    v_mul_f32 v56, v56, v55
    v_accvgpr_write_b32 a100, v56
    v_accvgpr_read_b32 v56, a101
    v_mul_f32 v56, v56, v55
    v_accvgpr_write_b32 a101, v56
    v_accvgpr_read_b32 v56, a102
    v_mul_f32 v56, v56, v55
    v_accvgpr_write_b32 a102, v56
    v_accvgpr_read_b32 v56, a103
    v_mul_f32 v56, v56, v55
    v_accvgpr_write_b32 a103, v56
    v_accvgpr_read_b32 v56, a104
    v_mul_f32 v56, v56, v55
    v_accvgpr_write_b32 a104, v56
    v_accvgpr_read_b32 v56, a105
    v_mul_f32 v56, v56, v55
    v_accvgpr_write_b32 a105, v56
    v_accvgpr_read_b32 v56, a106
    v_mul_f32 v56, v56, v55
    v_accvgpr_write_b32 a106, v56
    v_accvgpr_read_b32 v56, a107
    v_mul_f32 v56, v56, v55
    v_accvgpr_write_b32 a107, v56
    v_accvgpr_read_b32 v56, a108
    v_mul_f32 v56, v56, v55
    v_accvgpr_write_b32 a108, v56
    v_accvgpr_read_b32 v56, a109
    v_mul_f32 v56, v56, v55
    v_accvgpr_write_b32 a109, v56
    v_accvgpr_read_b32 v56, a110
    v_mul_f32 v56, v56, v55
    v_accvgpr_write_b32 a110, v56
    v_accvgpr_read_b32 v56, a111
    v_mul_f32 v56, v56, v55
    v_accvgpr_write_b32 a111, v56
    v_exp_f32 v216, v96
    v_exp_f32 v217, v97
    v_exp_f32 v218, v98
    v_exp_f32 v219, v99
    v_exp_f32 v220, v100
    v_exp_f32 v221, v101
    v_exp_f32 v222, v102
    v_exp_f32 v223, v103
    v_exp_f32 v224, v104
    v_exp_f32 v225, v105
    v_exp_f32 v226, v106
    v_exp_f32 v227, v107
    v_exp_f32 v228, v108
    v_exp_f32 v229, v109
    v_exp_f32 v230, v110
    v_exp_f32 v231, v111
    s_nop 0
    v_add_f32 v50, v216, v217
    v_add_f32 v50, v50, v218
    v_add_f32 v50, v50, v219
    v_add_f32 v50, v50, v220
    v_add_f32 v50, v50, v221
    v_add_f32 v50, v50, v222
    v_add_f32 v50, v50, v223
    v_add_f32 v50, v50, v224
    v_add_f32 v50, v50, v225
    v_add_f32 v50, v50, v226
    v_add_f32 v50, v50, v227
    v_add_f32 v50, v50, v228
    v_add_f32 v50, v50, v229
    v_add_f32 v50, v50, v230
    v_add_f32 v50, v50, v231
    v_cvt_pk_bf16_f32 v144, v216, v217
    v_cvt_pk_bf16_f32 v145, v218, v219
    v_cvt_pk_bf16_f32 v146, v220, v221
    v_cvt_pk_bf16_f32 v147, v222, v223
    v_cvt_pk_bf16_f32 v148, v224, v225
    v_cvt_pk_bf16_f32 v149, v226, v227
    v_cvt_pk_bf16_f32 v150, v228, v229
    v_cvt_pk_bf16_f32 v151, v230, v231
    v_max3_f32 v54, v112, v113, v114
    v_max3_f32 v54, v54, v115, v116
    v_max3_f32 v54, v54, v117, v118
    v_max3_f32 v54, v54, v119, v120
    v_max3_f32 v54, v54, v121, v122
    v_max3_f32 v54, v54, v123, v124
    v_max3_f32 v54, v54, v125, v126
    v_max_f32 v54, v54, v127
    v_mov_b32 v55, v54
    s_nop 1
    v_permlane32_swap_b32 v54, v55
    s_nop 1
    v_max3_f32 v54, v54, v55, 0
    v_sub_f32 v55, 0, v54
    v_exp_f32 v55, v55
    v_sub_f32 v176, v176, v54
    v_sub_f32 v112, v112, v54
    v_sub_f32 v80, v80, v54
    v_sub_f32 v177, v177, v54
    v_sub_f32 v113, v113, v54
    v_sub_f32 v81, v81, v54
    v_sub_f32 v178, v178, v54
    v_sub_f32 v114, v114, v54
    v_sub_f32 v82, v82, v54
    v_sub_f32 v179, v179, v54
    v_sub_f32 v115, v115, v54
    v_sub_f32 v83, v83, v54
    v_sub_f32 v180, v180, v54
    v_sub_f32 v116, v116, v54
    v_sub_f32 v84, v84, v54
    v_sub_f32 v181, v181, v54
    v_sub_f32 v117, v117, v54
    v_sub_f32 v85, v85, v54
    v_sub_f32 v182, v182, v54
    v_sub_f32 v118, v118, v54
    v_sub_f32 v86, v86, v54
    v_sub_f32 v183, v183, v54
    v_sub_f32 v119, v119, v54
    v_sub_f32 v87, v87, v54
    v_sub_f32 v184, v184, v54
    v_sub_f32 v120, v120, v54
    v_sub_f32 v88, v88, v54
    v_sub_f32 v185, v185, v54
    v_sub_f32 v121, v121, v54
    v_sub_f32 v89, v89, v54
    v_sub_f32 v186, v186, v54
    v_sub_f32 v122, v122, v54
    v_sub_f32 v90, v90, v54
    v_sub_f32 v187, v187, v54
    v_sub_f32 v123, v123, v54
    v_sub_f32 v91, v91, v54
    v_sub_f32 v188, v188, v54
    v_sub_f32 v124, v124, v54
    v_sub_f32 v92, v92, v54
    v_sub_f32 v189, v189, v54
    v_sub_f32 v125, v125, v54
    v_sub_f32 v93, v93, v54
    v_sub_f32 v190, v190, v54
    v_sub_f32 v126, v126, v54
    v_sub_f32 v94, v94, v54
    v_sub_f32 v191, v191, v54
    v_sub_f32 v127, v127, v54
    v_sub_f32 v95, v95, v54
    v_mul_f32 v53, v53, v55
    v_accvgpr_read_b32 v56, a16
    v_mul_f32 v56, v56, v55
    v_accvgpr_write_b32 a16, v56
    v_accvgpr_read_b32 v56, a17
    v_mul_f32 v56, v56, v55
    v_accvgpr_write_b32 a17, v56
    v_accvgpr_read_b32 v56, a18
    v_mul_f32 v56, v56, v55
    v_accvgpr_write_b32 a18, v56
    v_accvgpr_read_b32 v56, a19
    v_mul_f32 v56, v56, v55
    v_accvgpr_write_b32 a19, v56
    v_accvgpr_read_b32 v56, a20
    v_mul_f32 v56, v56, v55
    v_accvgpr_write_b32 a20, v56
    v_accvgpr_read_b32 v56, a21
    v_mul_f32 v56, v56, v55
    v_accvgpr_write_b32 a21, v56
    v_accvgpr_read_b32 v56, a22
    v_mul_f32 v56, v56, v55
    v_accvgpr_write_b32 a22, v56
    v_accvgpr_read_b32 v56, a23
    v_mul_f32 v56, v56, v55
    v_accvgpr_write_b32 a23, v56
    v_accvgpr_read_b32 v56, a24
    v_mul_f32 v56, v56, v55
    v_accvgpr_write_b32 a24, v56
    v_accvgpr_read_b32 v56, a25
    v_mul_f32 v56, v56, v55
    v_accvgpr_write_b32 a25, v56
    v_accvgpr_read_b32 v56, a26
    v_mul_f32 v56, v56, v55
    v_accvgpr_write_b32 a26, v56
    v_accvgpr_read_b32 v56, a27
    v_mul_f32 v56, v56, v55
    v_accvgpr_write_b32 a27, v56
    v_accvgpr_read_b32 v56, a28
    v_mul_f32 v56, v56, v55
    v_accvgpr_write_b32 a28, v56
    v_accvgpr_read_b32 v56, a29
    v_mul_f32 v56, v56, v55
    v_accvgpr_write_b32 a29, v56
    v_accvgpr_read_b32 v56, a30
    v_mul_f32 v56, v56, v55
    v_accvgpr_write_b32 a30, v56
    v_accvgpr_read_b32 v56, a31
    v_mul_f32 v56, v56, v55
    v_accvgpr_write_b32 a31, v56
    v_accvgpr_read_b32 v56, a48
    v_mul_f32 v56, v56, v55
    v_accvgpr_write_b32 a48, v56
    v_accvgpr_read_b32 v56, a49
    v_mul_f32 v56, v56, v55
    v_accvgpr_write_b32 a49, v56
    v_accvgpr_read_b32 v56, a50
    v_mul_f32 v56, v56, v55
    v_accvgpr_write_b32 a50, v56
    v_accvgpr_read_b32 v56, a51
    v_mul_f32 v56, v56, v55
    v_accvgpr_write_b32 a51, v56
    v_accvgpr_read_b32 v56, a52
    v_mul_f32 v56, v56, v55
    v_accvgpr_write_b32 a52, v56
    v_accvgpr_read_b32 v56, a53
    v_mul_f32 v56, v56, v55
    v_accvgpr_write_b32 a53, v56
    v_accvgpr_read_b32 v56, a54
    v_mul_f32 v56, v56, v55
    v_accvgpr_write_b32 a54, v56
    v_accvgpr_read_b32 v56, a55
    v_mul_f32 v56, v56, v55
    v_accvgpr_write_b32 a55, v56
    v_accvgpr_read_b32 v56, a56
    v_mul_f32 v56, v56, v55
    v_accvgpr_write_b32 a56, v56
    v_accvgpr_read_b32 v56, a57
    v_mul_f32 v56, v56, v55
    v_accvgpr_write_b32 a57, v56
    v_accvgpr_read_b32 v56, a58
    v_mul_f32 v56, v56, v55
    v_accvgpr_write_b32 a58, v56
    v_accvgpr_read_b32 v56, a59
    v_mul_f32 v56, v56, v55
    v_accvgpr_write_b32 a59, v56
    v_accvgpr_read_b32 v56, a60
    v_mul_f32 v56, v56, v55
    v_accvgpr_write_b32 a60, v56
    v_accvgpr_read_b32 v56, a61
    v_mul_f32 v56, v56, v55
    v_accvgpr_write_b32 a61, v56
    v_accvgpr_read_b32 v56, a62
    v_mul_f32 v56, v56, v55
    v_accvgpr_write_b32 a62, v56
    v_accvgpr_read_b32 v56, a63
    v_mul_f32 v56, v56, v55
    v_accvgpr_write_b32 a63, v56
    v_accvgpr_read_b32 v56, a80
    v_mul_f32 v56, v56, v55
    v_accvgpr_write_b32 a80, v56
    v_accvgpr_read_b32 v56, a81
    v_mul_f32 v56, v56, v55
    v_accvgpr_write_b32 a81, v56
    v_accvgpr_read_b32 v56, a82
    v_mul_f32 v56, v56, v55
    v_accvgpr_write_b32 a82, v56
    v_accvgpr_read_b32 v56, a83
    v_mul_f32 v56, v56, v55
    v_accvgpr_write_b32 a83, v56
    v_accvgpr_read_b32 v56, a84
    v_mul_f32 v56, v56, v55
    v_accvgpr_write_b32 a84, v56
    v_accvgpr_read_b32 v56, a85
    v_mul_f32 v56, v56, v55
    v_accvgpr_write_b32 a85, v56
    v_accvgpr_read_b32 v56, a86
    v_mul_f32 v56, v56, v55
    v_accvgpr_write_b32 a86, v56
    v_accvgpr_read_b32 v56, a87
    v_mul_f32 v56, v56, v55
    v_accvgpr_write_b32 a87, v56
    v_accvgpr_read_b32 v56, a88
    v_mul_f32 v56, v56, v55
    v_accvgpr_write_b32 a88, v56
    v_accvgpr_read_b32 v56, a89
    v_mul_f32 v56, v56, v55
    v_accvgpr_write_b32 a89, v56
    v_accvgpr_read_b32 v56, a90
    v_mul_f32 v56, v56, v55
    v_accvgpr_write_b32 a90, v56
    v_accvgpr_read_b32 v56, a91
    v_mul_f32 v56, v56, v55
    v_accvgpr_write_b32 a91, v56
    v_accvgpr_read_b32 v56, a92
    v_mul_f32 v56, v56, v55
    v_accvgpr_write_b32 a92, v56
    v_accvgpr_read_b32 v56, a93
    v_mul_f32 v56, v56, v55
    v_accvgpr_write_b32 a93, v56
    v_accvgpr_read_b32 v56, a94
    v_mul_f32 v56, v56, v55
    v_accvgpr_write_b32 a94, v56
    v_accvgpr_read_b32 v56, a95
    v_mul_f32 v56, v56, v55
    v_accvgpr_write_b32 a95, v56
    v_accvgpr_read_b32 v56, a112
    v_mul_f32 v56, v56, v55
    v_accvgpr_write_b32 a112, v56
    v_accvgpr_read_b32 v56, a113
    v_mul_f32 v56, v56, v55
    v_accvgpr_write_b32 a113, v56
    v_accvgpr_read_b32 v56, a114
    v_mul_f32 v56, v56, v55
    v_accvgpr_write_b32 a114, v56
    v_accvgpr_read_b32 v56, a115
    v_mul_f32 v56, v56, v55
    v_accvgpr_write_b32 a115, v56
    v_accvgpr_read_b32 v56, a116
    v_mul_f32 v56, v56, v55
    v_accvgpr_write_b32 a116, v56
    v_accvgpr_read_b32 v56, a117
    v_mul_f32 v56, v56, v55
    v_accvgpr_write_b32 a117, v56
    v_accvgpr_read_b32 v56, a118
    v_mul_f32 v56, v56, v55
    v_accvgpr_write_b32 a118, v56
    v_accvgpr_read_b32 v56, a119
    v_mul_f32 v56, v56, v55
    v_accvgpr_write_b32 a119, v56
    v_accvgpr_read_b32 v56, a120
    v_mul_f32 v56, v56, v55
    v_accvgpr_write_b32 a120, v56
    v_accvgpr_read_b32 v56, a121
    v_mul_f32 v56, v56, v55
    v_accvgpr_write_b32 a121, v56
    v_accvgpr_read_b32 v56, a122
    v_mul_f32 v56, v56, v55
    v_accvgpr_write_b32 a122, v56
    v_accvgpr_read_b32 v56, a123
    v_mul_f32 v56, v56, v55
    v_accvgpr_write_b32 a123, v56
    v_accvgpr_read_b32 v56, a124
    v_mul_f32 v56, v56, v55
    v_accvgpr_write_b32 a124, v56
    v_accvgpr_read_b32 v56, a125
    v_mul_f32 v56, v56, v55
    v_accvgpr_write_b32 a125, v56
    v_accvgpr_read_b32 v56, a126
    v_mul_f32 v56, v56, v55
    v_accvgpr_write_b32 a126, v56
    v_accvgpr_read_b32 v56, a127
    v_mul_f32 v56, v56, v55
    v_accvgpr_write_b32 a127, v56
    v_exp_f32 v216, v112
    v_exp_f32 v217, v113
    v_exp_f32 v218, v114
    v_exp_f32 v219, v115
    v_exp_f32 v220, v116
    v_exp_f32 v221, v117
    v_exp_f32 v222, v118
    v_exp_f32 v223, v119
    v_exp_f32 v224, v120
    v_exp_f32 v225, v121
    v_exp_f32 v226, v122
    v_exp_f32 v227, v123
    v_exp_f32 v228, v124
    v_exp_f32 v229, v125
    v_exp_f32 v230, v126
    v_exp_f32 v231, v127
    s_nop 0
    v_add_f32 v51, v216, v217
    v_add_f32 v51, v51, v218
    v_add_f32 v51, v51, v219
    v_add_f32 v51, v51, v220
    v_add_f32 v51, v51, v221
    v_add_f32 v51, v51, v222
    v_add_f32 v51, v51, v223
    v_add_f32 v51, v51, v224
    v_add_f32 v51, v51, v225
    v_add_f32 v51, v51, v226
    v_add_f32 v51, v51, v227
    v_add_f32 v51, v51, v228
    v_add_f32 v51, v51, v229
    v_add_f32 v51, v51, v230
    v_add_f32 v51, v51, v231
    v_cvt_pk_bf16_f32 v152, v216, v217
    v_cvt_pk_bf16_f32 v153, v218, v219
    v_cvt_pk_bf16_f32 v154, v220, v221
    v_cvt_pk_bf16_f32 v155, v222, v223
    v_cvt_pk_bf16_f32 v156, v224, v225
    v_cvt_pk_bf16_f32 v157, v226, v227
    v_cvt_pk_bf16_f32 v158, v228, v229
    v_cvt_pk_bf16_f32 v159, v230, v231
    s_nop 7
    s_setpc_b64 s[62:63]
F_end:
    s_endpgm
.section .rodata,"a"
.p2align 6
.amdhsa_kernel standalone__gqa_block_cached__near_ridge_kernel
  .amdhsa_next_free_vgpr 512
  .amdhsa_next_free_sgpr 102
  .amdhsa_accum_offset 256
  .amdhsa_group_segment_fixed_size 0
  .amdhsa_kernarg_size 64
  .amdhsa_user_sgpr_count 2
  .amdhsa_user_sgpr_kernarg_segment_ptr 1
  .amdhsa_system_sgpr_workgroup_id_x 1
  .amdhsa_float_denorm_mode_32 3
.end_amdhsa_kernel
```
